```python
import torch

def _softmax(x, axis=-1):
    return torch.softmax(x, dim=axis)
def _gelu(x):
    return torch.nn.functional.gelu(x, approximate="tanh")
def _silu(x):
    return torch.nn.functional.silu(x)
def _sigmoid(x):
    return torch.sigmoid(x)
def _layernorm(x, axis=-1, eps=1e-5):
    m = x.mean(dim=axis, keepdim=True)
    v = x.var(dim=axis, keepdim=True, unbiased=False)
    return (x - m) / torch.sqrt(v + eps)
def _scatter_add(tgt, idx, src, axis=0):
    return tgt.clone().index_add_(axis, idx, src)
def _segment_sum(src, seg, n):
    out = torch.zeros((n,) + src.shape[1:], dtype=src.dtype)
    return out.index_add_(0, seg, src)
def _pad(x, pw):
    flat = tuple(v for pair in reversed(pw) for v in pair)
    return torch.nn.functional.pad(x, flat)

kernel_name = 'parallel_sum__mha_block__dense_activation_squared_relu__prompt'

def setup_inputs():

    _w = (lambda a: (lambda t: t.to(torch.bfloat16) if t.is_floating_point() else t)(torch.as_tensor(a)))
    def _A_setup():
        B, S, D, H = 1, 2048, 448, 16
        return {
            "x": _w((lambda *s: torch.randn(*s, dtype=torch.bfloat16) * 0.05)(B, S, D)),
            "wqkv": _w((lambda *s: torch.randn(*s, dtype=torch.bfloat16) * 0.2)(D, 3 * D)),
            "wo": _w((lambda *s: torch.randn(*s, dtype=torch.bfloat16) * 0.1)(D, D)),
        }
    _A_in = _A_setup()

    def _B_setup():
        B, S, D, F = 1, 2048, 448, 1792
        return {
            "x": _w((lambda *s: torch.randn(*s, dtype=torch.bfloat16) * 0.05)(B, S, D)),
            "w1": _w((lambda *s: torch.randn(*s, dtype=torch.bfloat16) * 0.1)(D, F)),
            "b1": _w((lambda *s: torch.randn(*s, dtype=torch.bfloat16) * 0.8)(F)),
            "w2": _w((lambda *s: torch.randn(*s, dtype=torch.bfloat16) * 0.1)(F, D)),
            "b2": _w((lambda *s: torch.randn(*s, dtype=torch.bfloat16) * 12.8)(D)),
        }
    _B_in = _B_setup()

    return {
        "A_x": _A_in["x"],
        "A_wqkv": _A_in["wqkv"],
        "A_wo": _A_in["wo"],
        "B_x": _B_in["x"],
        "B_w1": _B_in["w1"],
        "B_b1": _B_in["b1"],
        "B_w2": _B_in["w2"],
        "B_b2": _B_in["b2"],
    }

def reference(A_x, A_wqkv, A_wo, B_x, B_w1, B_b1, B_w2, B_b2):
    def _A_ref(x, wqkv, wo):
        B, S, D = x.shape
        H = 16
        Dh = D // H
        qkv = (lambda x, *d: x.permute(*d))((x @ wqkv).reshape(B, S, 3, H, Dh), 2, 0, 3, 1, 4)
        q, k, v = qkv[0], qkv[1], qkv[2]
        scores = torch.einsum("bhqd,bhkd->bhqk", q, k) * (Dh ** -0.5)
        p = _softmax(scores, axis=-1)
        o = torch.einsum("bhqk,bhkd->bhqd", p, v)
        return (lambda x, *d: x.permute(*d))(o, 0, 2, 1, 3).reshape(B, S, D) @ wo

    def _B_ref(x, w1, b1, w2, b2):
        h = torch.einsum("bsd,df->bsf", x, w1) + b1
        zero = torch.zeros_like(h)
        r = torch.where(h > zero, h, zero)
        h = r * r
        out = torch.einsum("bsf,fd->bsd", h, w2) + b2
        return out

    x = A_x
    xn = _layernorm(x, axis=-1)
    return x + _A_ref(xn, A_wqkv, A_wo) + _B_ref(xn, B_w1, B_b1, B_w2, B_b2)
```

```asm
; @launch grid=(256,1,1) block=(512,1,1) lds=163840
.amdgcn_target "amdgcn-amd-amdhsa--gfx950"
.text
.globl parallel_sum__mha_block__dense_activation_squared_relu__prompt_kernel
.p2align 8
.type parallel_sum__mha_block__dense_activation_squared_relu__prompt_kernel,@function
parallel_sum__mha_block__dense_activation_squared_relu__prompt_kernel:
    s_cmp_ge_u32 s2, 256
    s_cbranch_scc1 L1_end
    s_load_dwordx16 s[16:31], s[0:1], 0
    s_load_dwordx2 s[32:33], s[0:1], 80
    s_load_dwordx4 s[88:91], s[0:1], 64
    s_memrealtime s[94:95]
    s_and_b32 s3, s2, 7
    s_lshr_b32 s4, s2, 3
    s_and_b32 s5, s3, 3
    s_lshl_b32 s5, s5, 2
    s_and_b32 s6, s4, 3
    s_add_u32 s34, s5, s6
    s_lshr_b32 s6, s3, 2
    s_lshl_b32 s6, s6, 3
    s_lshr_b32 s7, s4, 2
    s_add_u32 s35, s6, s7
    v_lshrrev_b32 v1, 6, v0
    v_and_b32 v2, 63, v0
    v_readfirstlane_b32 s37, v1
    v_lshlrev_b32 v250, 4, v2
    s_mov_b32 s73, 0x3f803f80
    s_lshr_b32 s87, s37, 2
    s_and_b32 s37, s37, 3
    s_mov_b32 s92, 0xffff0000
    s_lshr_b32 s10, s35, 1
    s_mul_i32 s10, s10, 7
    s_and_b32 s11, s35, 1
    s_sub_u32 s61, 4, s11
    s_lshl_b32 s11, s11, 2
    s_add_u32 s60, s10, s11
    v_lshlrev_b32 v2, 2, v2
    v_add_u32 v2, 163328, v2
    v_mov_b32 v3, 0
    ds_write_b32 v2, v3
    s_waitcnt lgkmcnt(0)
    s_mov_b32 s40, s16
    s_mov_b32 s41, s17
    s_mov_b32 s42, 1835008
    s_mov_b32 s43, 0x20000
    s_mov_b32 s48, s32
    s_mov_b32 s49, s33
    s_mov_b32 s50, 33554432
    s_mov_b32 s51, 0x20000
    s_or_b32 s100, s94, 1
    s_or_b32 s12, s2, s37
    s_or_b32 s12, s12, s87
    s_cmp_lg_u32 s12, 0
    s_cbranch_scc1 L1_notag
    s_mov_b32 s52, s90
    s_mov_b32 s53, s91
    s_mov_b32 s54, 256
    s_mov_b32 s55, 0x20000
    v_mov_b32 v2, s100
    v_mov_b32 v3, 0
    s_mov_b64 exec, 1
    buffer_store_dword v2, v3, s[52:55], 0 offen sc0 sc1
    s_mov_b64 exec, -1
L1_notag:
    s_cmp_eq_u32 s87, 0
    s_cbranch_scc1 L1_compute
    s_setprio 3
    v_and_b32 v96, 63, v0
    s_lshr_b32 s12, s2, 5
    s_lshl_b32 s12, s12, 4
    s_lshl_b32 s13, s37, 2
    s_add_u32 s12, s12, s13
    s_lshl_b32 s13, s34, 7
    s_add_u32 s12, s12, s13
    s_mul_i32 s12, s12, 896
    buffer_load_dwordx4 v[8:11], v250, s[40:43], s12 offen offset:0
    buffer_load_dwordx4 v[8:11], v250, s[40:43], s12 offen offset:1024
    buffer_load_dwordx4 v[8:11], v250, s[40:43], s12 offen offset:2048
    buffer_load_dwordx4 v[8:11], v250, s[40:43], s12 offen offset:2560
    v_lshrrev_b32 v97, 3, v96
    v_lshrrev_b32 v98, 4, v96
    v_and_b32 v99, 7, v96
    v_mul_u32_u24 v101, 896, v97
    v_xor_b32 v100, v99, v98
    v_lshlrev_b32 v100, 4, v100
    v_add_u32 v100, v100, v101
    v_add_u32 v72, 0, v100
    v_xor_b32 v100, v99, v98
    v_xor_b32 v100, 4, v100
    v_lshlrev_b32 v100, 4, v100
    v_add_u32 v100, v100, v101
    v_add_u32 v73, 6144, v100
    v_xor_b32 v100, v99, v98
    v_lshlrev_b32 v100, 4, v100
    v_add_u32 v100, v100, v101
    v_add_u32 v74, 12288, v100
    v_xor_b32 v100, v99, v98
    v_xor_b32 v100, 4, v100
    v_lshlrev_b32 v100, 4, v100
    v_add_u32 v100, v100, v101
    v_add_u32 v75, 18432, v100
    s_lshl_b32 s12, s34, 7
    s_lshl_b32 s13, s37, 5
    s_add_u32 s12, s12, s13
    s_mul_i32 s56, s12, 896
    s_lshl_b32 s13, s37, 12
    s_add_u32 m0, s13, 0
    s_nop 0
    buffer_load_dwordx4 v72, s[40:43], s56 offen offset:0 lds
    buffer_load_dwordx4 v73, s[40:43], s56 offen offset:1024 lds
    buffer_load_dwordx4 v74, s[40:43], s56 offen offset:2048 lds
    buffer_load_dwordx4 v75, s[40:43], s56 offen offset:3072 lds
    s_add_u32 m0, s13, 16384
    s_add_u32 s56, s56, 128
    buffer_load_dwordx4 v72, s[40:43], s56 offen offset:0 lds
    buffer_load_dwordx4 v73, s[40:43], s56 offen offset:1024 lds
    buffer_load_dwordx4 v74, s[40:43], s56 offen offset:2048 lds
    buffer_load_dwordx4 v75, s[40:43], s56 offen offset:3072 lds
    s_add_u32 m0, s13, 32768
    s_add_u32 s56, s56, 128
    buffer_load_dwordx4 v72, s[40:43], s56 offen offset:0 lds
    buffer_load_dwordx4 v73, s[40:43], s56 offen offset:1024 lds
    buffer_load_dwordx4 v74, s[40:43], s56 offen offset:2048 lds
    buffer_load_dwordx4 v75, s[40:43], s56 offen offset:3072 lds
    s_add_u32 m0, s13, 49152
    s_add_u32 s56, s56, 128
    buffer_load_dwordx4 v72, s[40:43], s56 offen offset:0 lds
    buffer_load_dwordx4 v73, s[40:43], s56 offen offset:1024 lds
    buffer_load_dwordx4 v74, s[40:43], s56 offen offset:2048 lds
    buffer_load_dwordx4 v75, s[40:43], s56 offen offset:3072 lds
    s_barrier
    v_lshrrev_b32 v97, 5, v96
    v_and_b32 v98, 31, v96
    v_bfe_u32 v99, v98, 1, 3
    v_lshlrev_b32 v100, 7, v98
    s_lshl_b32 s12, s37, 12
    v_add_u32 v100, s12, v100
    v_add_u32 v101, 0, v97
    v_xor_b32 v101, v101, v99
    v_lshlrev_b32 v101, 4, v101
    v_add_u32 v76, v100, v101
    v_add_u32 v101, 2, v97
    v_xor_b32 v101, v101, v99
    v_lshlrev_b32 v101, 4, v101
    v_add_u32 v77, v100, v101
    v_add_u32 v101, 4, v97
    v_xor_b32 v101, v101, v99
    v_lshlrev_b32 v101, 4, v101
    v_add_u32 v78, v100, v101
    v_add_u32 v101, 6, v97
    v_xor_b32 v101, v101, v99
    v_lshlrev_b32 v101, 4, v101
    v_add_u32 v79, v100, v101
    s_lshl_b32 s13, s37, 12
    v_add_u32 v80, 65536, v76
    v_add_u32 v81, 65536, v77
    v_add_u32 v82, 65536, v78
    v_add_u32 v83, 65536, v79
    v_mov_b32 v84, 0
    v_mov_b32 v85, 0
    s_waitcnt vmcnt(12)
    ds_read_b128 v[128:131], v76 offset:0
    ds_read_b128 v[132:135], v77 offset:0
    ds_read_b128 v[136:139], v78 offset:0
    ds_read_b128 v[140:143], v79 offset:0
    s_add_u32 m0, s13, 65536
    s_add_u32 s56, s56, 128
    buffer_load_dwordx4 v72, s[40:43], s56 offen offset:0 lds
    buffer_load_dwordx4 v73, s[40:43], s56 offen offset:1024 lds
    buffer_load_dwordx4 v74, s[40:43], s56 offen offset:2048 lds
    buffer_load_dwordx4 v75, s[40:43], s56 offen offset:3072 lds
    s_waitcnt vmcnt(12)
    ds_read_b128 v[144:147], v76 offset:16384
    ds_read_b128 v[148:151], v77 offset:16384
    ds_read_b128 v[152:155], v78 offset:16384
    ds_read_b128 v[156:159], v79 offset:16384
    s_waitcnt lgkmcnt(4)
    v_dot2c_f32_bf16 v84, s73, v128
    v_dot2c_f32_bf16 v85, v128, v128
    v_dot2c_f32_bf16 v84, s73, v129
    v_dot2c_f32_bf16 v85, v129, v129
    v_dot2c_f32_bf16 v84, s73, v130
    v_dot2c_f32_bf16 v85, v130, v130
    v_dot2c_f32_bf16 v84, s73, v131
    v_dot2c_f32_bf16 v85, v131, v131
    v_dot2c_f32_bf16 v84, s73, v132
    v_dot2c_f32_bf16 v85, v132, v132
    v_dot2c_f32_bf16 v84, s73, v133
    v_dot2c_f32_bf16 v85, v133, v133
    v_dot2c_f32_bf16 v84, s73, v134
    v_dot2c_f32_bf16 v85, v134, v134
    v_dot2c_f32_bf16 v84, s73, v135
    v_dot2c_f32_bf16 v85, v135, v135
    v_dot2c_f32_bf16 v84, s73, v136
    v_dot2c_f32_bf16 v85, v136, v136
    v_dot2c_f32_bf16 v84, s73, v137
    v_dot2c_f32_bf16 v85, v137, v137
    v_dot2c_f32_bf16 v84, s73, v138
    v_dot2c_f32_bf16 v85, v138, v138
    v_dot2c_f32_bf16 v84, s73, v139
    v_dot2c_f32_bf16 v85, v139, v139
    v_dot2c_f32_bf16 v84, s73, v140
    v_dot2c_f32_bf16 v85, v140, v140
    v_dot2c_f32_bf16 v84, s73, v141
    v_dot2c_f32_bf16 v85, v141, v141
    v_dot2c_f32_bf16 v84, s73, v142
    v_dot2c_f32_bf16 v85, v142, v142
    v_dot2c_f32_bf16 v84, s73, v143
    v_dot2c_f32_bf16 v85, v143, v143
    s_add_u32 m0, s13, 81920
    s_add_u32 s56, s56, 128
    buffer_load_dwordx4 v72, s[40:43], s56 offen offset:0 lds
    buffer_load_dwordx4 v73, s[40:43], s56 offen offset:1024 lds
    buffer_load_dwordx4 v74, s[40:43], s56 offen offset:2048 lds
    buffer_load_dwordx4 v75, s[40:43], s56 offen offset:3072 lds
    s_waitcnt vmcnt(12)
    ds_read_b128 v[160:163], v76 offset:32768
    ds_read_b128 v[164:167], v77 offset:32768
    ds_read_b128 v[168:171], v78 offset:32768
    ds_read_b128 v[172:175], v79 offset:32768
    s_waitcnt lgkmcnt(4)
    v_dot2c_f32_bf16 v84, s73, v144
    v_dot2c_f32_bf16 v85, v144, v144
    v_dot2c_f32_bf16 v84, s73, v145
    v_dot2c_f32_bf16 v85, v145, v145
    v_dot2c_f32_bf16 v84, s73, v146
    v_dot2c_f32_bf16 v85, v146, v146
    v_dot2c_f32_bf16 v84, s73, v147
    v_dot2c_f32_bf16 v85, v147, v147
    v_dot2c_f32_bf16 v84, s73, v148
    v_dot2c_f32_bf16 v85, v148, v148
    v_dot2c_f32_bf16 v84, s73, v149
    v_dot2c_f32_bf16 v85, v149, v149
    v_dot2c_f32_bf16 v84, s73, v150
    v_dot2c_f32_bf16 v85, v150, v150
    v_dot2c_f32_bf16 v84, s73, v151
    v_dot2c_f32_bf16 v85, v151, v151
    v_dot2c_f32_bf16 v84, s73, v152
    v_dot2c_f32_bf16 v85, v152, v152
    v_dot2c_f32_bf16 v84, s73, v153
    v_dot2c_f32_bf16 v85, v153, v153
    v_dot2c_f32_bf16 v84, s73, v154
    v_dot2c_f32_bf16 v85, v154, v154
    v_dot2c_f32_bf16 v84, s73, v155
    v_dot2c_f32_bf16 v85, v155, v155
    v_dot2c_f32_bf16 v84, s73, v156
    v_dot2c_f32_bf16 v85, v156, v156
    v_dot2c_f32_bf16 v84, s73, v157
    v_dot2c_f32_bf16 v85, v157, v157
    v_dot2c_f32_bf16 v84, s73, v158
    v_dot2c_f32_bf16 v85, v158, v158
    v_dot2c_f32_bf16 v84, s73, v159
    v_dot2c_f32_bf16 v85, v159, v159
    s_add_u32 m0, s13, 98304
    s_add_u32 s56, s56, 128
    buffer_load_dwordx4 v72, s[40:43], s56 offen offset:0 lds
    buffer_load_dwordx4 v73, s[40:43], s56 offen offset:1024 lds
    buffer_load_dwordx4 v74, s[40:43], s56 offen offset:2048 lds
    buffer_load_dwordx4 v75, s[40:43], s56 offen offset:3072 lds
    s_lshl_b32 s12, s37, 2
    s_add_u32 s12, s12, 163440
    v_mov_b32 v104, s12
    v_mov_b32 v105, 1
    ds_write_b32 v104, v105
    s_waitcnt vmcnt(12)
    ds_read_b128 v[176:179], v76 offset:49152
    ds_read_b128 v[180:183], v77 offset:49152
    ds_read_b128 v[184:187], v78 offset:49152
    ds_read_b128 v[188:191], v79 offset:49152
    s_waitcnt lgkmcnt(4)
    v_dot2c_f32_bf16 v84, s73, v160
    v_dot2c_f32_bf16 v85, v160, v160
    v_dot2c_f32_bf16 v84, s73, v161
    v_dot2c_f32_bf16 v85, v161, v161
    v_dot2c_f32_bf16 v84, s73, v162
    v_dot2c_f32_bf16 v85, v162, v162
    v_dot2c_f32_bf16 v84, s73, v163
    v_dot2c_f32_bf16 v85, v163, v163
    v_dot2c_f32_bf16 v84, s73, v164
    v_dot2c_f32_bf16 v85, v164, v164
    v_dot2c_f32_bf16 v84, s73, v165
    v_dot2c_f32_bf16 v85, v165, v165
    v_dot2c_f32_bf16 v84, s73, v166
    v_dot2c_f32_bf16 v85, v166, v166
    v_dot2c_f32_bf16 v84, s73, v167
    v_dot2c_f32_bf16 v85, v167, v167
    v_dot2c_f32_bf16 v84, s73, v168
    v_dot2c_f32_bf16 v85, v168, v168
    v_dot2c_f32_bf16 v84, s73, v169
    v_dot2c_f32_bf16 v85, v169, v169
    v_dot2c_f32_bf16 v84, s73, v170
    v_dot2c_f32_bf16 v85, v170, v170
    v_dot2c_f32_bf16 v84, s73, v171
    v_dot2c_f32_bf16 v85, v171, v171
    v_dot2c_f32_bf16 v84, s73, v172
    v_dot2c_f32_bf16 v85, v172, v172
    v_dot2c_f32_bf16 v84, s73, v173
    v_dot2c_f32_bf16 v85, v173, v173
    v_dot2c_f32_bf16 v84, s73, v174
    v_dot2c_f32_bf16 v85, v174, v174
    v_dot2c_f32_bf16 v84, s73, v175
    v_dot2c_f32_bf16 v85, v175, v175
    s_waitcnt vmcnt(8)
    ds_read_b128 v[192:195], v80 offset:0
    ds_read_b128 v[196:199], v81 offset:0
    ds_read_b128 v[200:203], v82 offset:0
    ds_read_b128 v[204:207], v83 offset:0
    s_waitcnt lgkmcnt(4)
    v_dot2c_f32_bf16 v84, s73, v176
    v_dot2c_f32_bf16 v85, v176, v176
    v_dot2c_f32_bf16 v84, s73, v177
    v_dot2c_f32_bf16 v85, v177, v177
    v_dot2c_f32_bf16 v84, s73, v178
    v_dot2c_f32_bf16 v85, v178, v178
    v_dot2c_f32_bf16 v84, s73, v179
    v_dot2c_f32_bf16 v85, v179, v179
    v_dot2c_f32_bf16 v84, s73, v180
    v_dot2c_f32_bf16 v85, v180, v180
    v_dot2c_f32_bf16 v84, s73, v181
    v_dot2c_f32_bf16 v85, v181, v181
    v_dot2c_f32_bf16 v84, s73, v182
    v_dot2c_f32_bf16 v85, v182, v182
    v_dot2c_f32_bf16 v84, s73, v183
    v_dot2c_f32_bf16 v85, v183, v183
    v_dot2c_f32_bf16 v84, s73, v184
    v_dot2c_f32_bf16 v85, v184, v184
    v_dot2c_f32_bf16 v84, s73, v185
    v_dot2c_f32_bf16 v85, v185, v185
    v_dot2c_f32_bf16 v84, s73, v186
    v_dot2c_f32_bf16 v85, v186, v186
    v_dot2c_f32_bf16 v84, s73, v187
    v_dot2c_f32_bf16 v85, v187, v187
    v_dot2c_f32_bf16 v84, s73, v188
    v_dot2c_f32_bf16 v85, v188, v188
    v_dot2c_f32_bf16 v84, s73, v189
    v_dot2c_f32_bf16 v85, v189, v189
    v_dot2c_f32_bf16 v84, s73, v190
    v_dot2c_f32_bf16 v85, v190, v190
    v_dot2c_f32_bf16 v84, s73, v191
    v_dot2c_f32_bf16 v85, v191, v191
    s_waitcnt vmcnt(4)
    ds_read_b128 v[208:211], v80 offset:16384
    ds_read_b128 v[212:215], v81 offset:16384
    ds_read_b128 v[216:219], v82 offset:16384
    ds_read_b128 v[220:223], v83 offset:16384
    s_waitcnt lgkmcnt(4)
    v_dot2c_f32_bf16 v84, s73, v192
    v_dot2c_f32_bf16 v85, v192, v192
    v_dot2c_f32_bf16 v84, s73, v193
    v_dot2c_f32_bf16 v85, v193, v193
    v_dot2c_f32_bf16 v84, s73, v194
    v_dot2c_f32_bf16 v85, v194, v194
    v_dot2c_f32_bf16 v84, s73, v195
    v_dot2c_f32_bf16 v85, v195, v195
    v_dot2c_f32_bf16 v84, s73, v196
    v_dot2c_f32_bf16 v85, v196, v196
    v_dot2c_f32_bf16 v84, s73, v197
    v_dot2c_f32_bf16 v85, v197, v197
    v_dot2c_f32_bf16 v84, s73, v198
    v_dot2c_f32_bf16 v85, v198, v198
    v_dot2c_f32_bf16 v84, s73, v199
    v_dot2c_f32_bf16 v85, v199, v199
    v_dot2c_f32_bf16 v84, s73, v200
    v_dot2c_f32_bf16 v85, v200, v200
    v_dot2c_f32_bf16 v84, s73, v201
    v_dot2c_f32_bf16 v85, v201, v201
    v_dot2c_f32_bf16 v84, s73, v202
    v_dot2c_f32_bf16 v85, v202, v202
    v_dot2c_f32_bf16 v84, s73, v203
    v_dot2c_f32_bf16 v85, v203, v203
    v_dot2c_f32_bf16 v84, s73, v204
    v_dot2c_f32_bf16 v85, v204, v204
    v_dot2c_f32_bf16 v84, s73, v205
    v_dot2c_f32_bf16 v85, v205, v205
    v_dot2c_f32_bf16 v84, s73, v206
    v_dot2c_f32_bf16 v85, v206, v206
    v_dot2c_f32_bf16 v84, s73, v207
    v_dot2c_f32_bf16 v85, v207, v207
    s_waitcnt vmcnt(0)
    s_lshl_b32 s12, s37, 2
    s_add_u32 s12, s12, 163476
    v_mov_b32 v104, s12
    v_mov_b32 v105, 1
    ds_write_b32 v104, v105
    ds_read_b128 v[224:227], v80 offset:32768
    ds_read_b128 v[228:231], v81 offset:32768
    ds_read_b128 v[232:235], v82 offset:32768
    ds_read_b128 v[236:239], v83 offset:32768
    s_waitcnt lgkmcnt(4)
    v_dot2c_f32_bf16 v84, s73, v208
    v_dot2c_f32_bf16 v85, v208, v208
    v_dot2c_f32_bf16 v84, s73, v209
    v_dot2c_f32_bf16 v85, v209, v209
    v_dot2c_f32_bf16 v84, s73, v210
    v_dot2c_f32_bf16 v85, v210, v210
    v_dot2c_f32_bf16 v84, s73, v211
    v_dot2c_f32_bf16 v85, v211, v211
    v_dot2c_f32_bf16 v84, s73, v212
    v_dot2c_f32_bf16 v85, v212, v212
    v_dot2c_f32_bf16 v84, s73, v213
    v_dot2c_f32_bf16 v85, v213, v213
    v_dot2c_f32_bf16 v84, s73, v214
    v_dot2c_f32_bf16 v85, v214, v214
    v_dot2c_f32_bf16 v84, s73, v215
    v_dot2c_f32_bf16 v85, v215, v215
    v_dot2c_f32_bf16 v84, s73, v216
    v_dot2c_f32_bf16 v85, v216, v216
    v_dot2c_f32_bf16 v84, s73, v217
    v_dot2c_f32_bf16 v85, v217, v217
    v_dot2c_f32_bf16 v84, s73, v218
    v_dot2c_f32_bf16 v85, v218, v218
    v_dot2c_f32_bf16 v84, s73, v219
    v_dot2c_f32_bf16 v85, v219, v219
    v_dot2c_f32_bf16 v84, s73, v220
    v_dot2c_f32_bf16 v85, v220, v220
    v_dot2c_f32_bf16 v84, s73, v221
    v_dot2c_f32_bf16 v85, v221, v221
    v_dot2c_f32_bf16 v84, s73, v222
    v_dot2c_f32_bf16 v85, v222, v222
    v_dot2c_f32_bf16 v84, s73, v223
    v_dot2c_f32_bf16 v85, v223, v223
    s_waitcnt lgkmcnt(0)
    v_dot2c_f32_bf16 v84, s73, v224
    v_dot2c_f32_bf16 v85, v224, v224
    v_dot2c_f32_bf16 v84, s73, v225
    v_dot2c_f32_bf16 v85, v225, v225
    v_dot2c_f32_bf16 v84, s73, v226
    v_dot2c_f32_bf16 v85, v226, v226
    v_dot2c_f32_bf16 v84, s73, v227
    v_dot2c_f32_bf16 v85, v227, v227
    v_dot2c_f32_bf16 v84, s73, v228
    v_dot2c_f32_bf16 v85, v228, v228
    v_dot2c_f32_bf16 v84, s73, v229
    v_dot2c_f32_bf16 v85, v229, v229
    v_dot2c_f32_bf16 v84, s73, v230
    v_dot2c_f32_bf16 v85, v230, v230
    v_dot2c_f32_bf16 v84, s73, v231
    v_dot2c_f32_bf16 v85, v231, v231
    v_dot2c_f32_bf16 v84, s73, v232
    v_dot2c_f32_bf16 v85, v232, v232
    v_dot2c_f32_bf16 v84, s73, v233
    v_dot2c_f32_bf16 v85, v233, v233
    v_dot2c_f32_bf16 v84, s73, v234
    v_dot2c_f32_bf16 v85, v234, v234
    v_dot2c_f32_bf16 v84, s73, v235
    v_dot2c_f32_bf16 v85, v235, v235
    v_dot2c_f32_bf16 v84, s73, v236
    v_dot2c_f32_bf16 v85, v236, v236
    v_dot2c_f32_bf16 v84, s73, v237
    v_dot2c_f32_bf16 v85, v237, v237
    v_dot2c_f32_bf16 v84, s73, v238
    v_dot2c_f32_bf16 v85, v238, v238
    v_dot2c_f32_bf16 v84, s73, v239
    v_dot2c_f32_bf16 v85, v239, v239
    s_nop 2
    v_mov_b32 v112, v84
    v_mov_b32 v113, v85
    s_nop 1
    v_permlane32_swap_b32 v84, v112
    v_permlane32_swap_b32 v85, v113
    s_nop 1
    v_add_f32 v84, v84, v112
    v_add_f32 v85, v85, v113
    v_mul_f32 v84, 0x3b124925, v84
    v_mul_f32 v85, 0x3b124925, v85
    v_fma_f32 v85, -v84, v84, v85
    v_max_f32 v85, 0, v85
    v_add_f32 v85, 0x3727c5ac, v85
    v_rsq_f32 v86, v85
    s_lshl_b32 s12, s37, 2
    s_add_u32 s12, s12, 163360
    v_mov_b32 v104, s12
    v_mul_f32 v87, v84, v86
    v_sub_f32 v87, 0, v87
    v_mul_f32 v87, -1.0, v84
    v_and_b32 v98, 31, v0
    v_lshlrev_b32 v98, 2, v98
    s_lshl_b32 s12, s37, 7
    s_add_u32 s12, s12, 147456
    v_add_u32 v98, s12, v98
    ds_write_b32 v98, v87
    ds_write_b32 v98, v86 offset:512
    s_lshl_b32 s12, s37, 2
    s_add_u32 s12, s12, 163424
    v_mov_b32 v100, s12
    v_mov_b32 v101, 1
    ds_write_b32 v100, v101
    s_setprio 0
    s_mov_b32 s80, s90
    s_mov_b32 s81, s91
    s_mov_b32 s82, 256
    s_mov_b32 s83, 0x20000
    v_mov_b32 v107, 0
    buffer_load_dword v106, v107, s[80:83], 0 offen sc1
    v_lshrrev_b32 v108, 5, v96
    v_lshlrev_b32 v108, 5, v108
    v_bfe_u32 v109, v96, 4, 1
    v_add_u32 v108, v108, v109
    v_and_b32 v109, 15, v96
    v_lshlrev_b32 v109, 4, v109
    v_mul_u32_u24 v110, 2688, v108
    v_add_u32 v110, v110, v109
    v_mul_u32_u24 v111, 3584, v108
    v_add_u32 v111, v111, v109
    s_and_b32 s12, s34, 3
    s_lshl_b32 s12, s12, 2
    s_add_u32 s12, s12, s37
    s_lshl_b32 s12, s12, 1
    s_add_u32 s14, s12, 128
    s_mul_i32 s76, s14, 2688
    s_mul_i32 s14, s35, 168
    s_and_b32 s14, s14, -16
    s_add_u32 s76, s76, s14
    s_mul_i32 s77, s12, 3584
    s_lshl_b32 s14, s60, 6
    s_add_u32 s77, s77, s14
    v_mov_b32 v100, 163492
    s_mov_b32 s13, 1048576
L1_fgw:
    ds_read_b32 v101, v100
    s_waitcnt lgkmcnt(0)
    v_readfirstlane_b32 s12, v101
    s_nop 3
    s_cmp_lg_u32 s12, 0
    s_cbranch_scc1 L1_fgx
    s_sleep 3
    s_sub_u32 s13, s13, 1
    s_cmp_lg_u32 s13, 0
    s_cbranch_scc1 L1_fgw
L1_fgx:
    s_mov_b32 s44, s24
    s_mov_b32 s45, s25
    s_mov_b32 s46, 1605632
    s_mov_b32 s47, 0x20000
    buffer_load_dwordx4 v[8:11], v111, s[44:47], s77 offen
    s_add_u32 s77, s77, 229376
    buffer_load_dwordx4 v[8:11], v111, s[44:47], s77 offen
    s_add_u32 s77, s77, 229376
    buffer_load_dwordx4 v[8:11], v111, s[44:47], s77 offen
    s_add_u32 s77, s77, 229376
    buffer_load_dwordx4 v[8:11], v111, s[44:47], s77 offen
    s_add_u32 s77, s77, 229376
    buffer_load_dwordx4 v[8:11], v111, s[44:47], s77 offen
    s_add_u32 s77, s77, 229376
    buffer_load_dwordx4 v[8:11], v111, s[44:47], s77 offen
    s_add_u32 s77, s77, 229376
    buffer_load_dwordx4 v[8:11], v111, s[44:47], s77 offen
    s_add_u32 s77, s77, 229376
    s_waitcnt vmcnt(0)
    v_readfirstlane_b32 s100, v106
    s_nop 3
    s_cmp_lg_u32 s100, 0
    s_cbranch_scc1 L1_htag
    s_mov_b32 s80, s90
    s_mov_b32 s81, s91
    s_mov_b32 s82, 256
    s_mov_b32 s83, 0x20000
    s_mov_b32 s84, 262144
    v_mov_b32 v3, 0
LT1:
    buffer_load_dword v2, v3, s[80:83], 0 offen sc1
    s_waitcnt vmcnt(0)
    v_readfirstlane_b32 s100, v2
    s_nop 3
    s_cmp_lg_u32 s100, 0
    s_cbranch_scc1 LT1x
    s_sleep 2
    s_sub_u32 s84, s84, 1
    s_cmp_lg_u32 s84, 0
    s_cbranch_scc1 LT1
LT1x:
L1_htag:
    v_mov_b32 v2, 163456
    v_mov_b32 v3, s100
    ds_write_b32 v2, v3
    s_setprio 2
L1_hs_h:
    s_cmp_lt_u32 s2, 196
    s_cselect_b32 s52, s28, s20
    s_cselect_b32 s53, s29, s21
    s_cselect_b32 s12, 0, 196
    s_mov_b32 s54, 401408
    s_cselect_b32 s54, 1605632, s54
    s_mov_b32 s55, 0x20000
    s_sub_u32 s12, s2, s12
    s_cmp_ge_u32 s2, 245
    s_cselect_b32 s12, 0, s12
    s_cselect_b32 s54, 0, s54
    s_lshl_b32 s12, s12, 13
    s_lshl_b32 s13, s37, 11
    s_add_u32 s12, s12, s13
    buffer_load_dwordx4 v[8:11], v250, s[52:55], s12 offen
    buffer_load_dwordx4 v[8:11], v250, s[52:55], s12 offen offset:1024
    s_cmp_lg_u32 s37, 3
    s_cbranch_scc1 L2_attn_entry
    v_mov_b32 v100, 163460
    s_mov_b32 s13, 1048576
L1_rdw:
    ds_read_b32 v101, v100
    s_waitcnt lgkmcnt(0)
    v_readfirstlane_b32 s12, v101
    s_nop 3
    s_cmp_lg_u32 s12, 0
    s_cbranch_scc1 L1_rdx
    s_sleep 3
    s_sub_u32 s13, s13, 1
    s_cmp_lg_u32 s13, 0
    s_cbranch_scc1 L1_rdw
L1_rdx:
    s_mov_b32 s8, s34
    s_mov_b32 s9, s35
    s_and_b32 s38, s2, 7
    s_lshr_b32 s39, s2, 3
    s_lshr_b32 s3, s39, 4
    s_lshl_b32 s34, s38, 1
    s_add_u32 s34, s34, s3
    s_and_b32 s35, s39, 15
    v_and_b32 v1, 63, v0
    v_lshlrev_b32 v1, 4, v1
    s_mov_b32 s64, 0
    s_mov_b32 s65, -1
    s_add_u32 s75, s34, 0
    s_mul_i32 s75, s75, 43
    s_lshr_b32 s75, s75, 7
    s_add_u32 s76, s34, 16
    s_mul_i32 s76, s76, 43
    s_lshr_b32 s76, s76, 7
    s_add_u32 s77, s34, 32
    s_mul_i32 s77, s77, 43
    s_lshr_b32 s77, s77, 7
    v_lshrrev_b32 v100, 4, v1
    v_and_b32 v101, 15, v100
    v_lshlrev_b32 v101, 2, v101
    s_lshl_b32 s76, s76, 8
    s_lshl_b32 s77, s77, 8
    s_lshl_b32 s75, s75, 8
    s_lshl_b32 s78, s35, 2
    s_add_u32 s75, s75, s78
    v_add_u32 v102, s76, v101
    v_add_u32 v103, s77, v101
    v_mov_b32 v104, s75
    v_cmp_gt_u32 vcc, 16, v100
    s_nop 1
    v_cndmask_b32 v103, v103, v102, vcc
    v_cmp_gt_u32 vcc, 32, v100
    s_nop 1
    v_cndmask_b32 v104, v104, v103, vcc
    s_mov_b32 s78, 262144
    s_mov_b32 s79, 27262976
LP2:
    buffer_load_dword v105, v104, s[48:51], s79 offen sc1
    s_waitcnt vmcnt(0)
    v_cmp_ne_u32 vcc, s100, v105
    s_cbranch_vccz LP2x
    s_sleep 2
    s_sub_u32 s78, s78, 1
    s_cmp_lg_u32 s78, 0
    s_cbranch_scc1 LP2
LP2x:
    v_mov_b32 v100, 163332
    v_mov_b32 v101, s100
    ds_write_b32 v100, v101
    s_mov_b32 s34, s8
    s_mov_b32 s35, s9
    s_branch L2_attn_entry
L1_compute:
    s_barrier
    s_cmp_lg_u32 s37, 3
    s_cbranch_scc1 L1_nopf
    s_lshr_b32 s6, s2, 3
    s_cmp_ge_u32 s6, (L_CODE_END - parallel_sum__mha_block__dense_activation_squared_relu__prompt_kernel) / 1024
    s_cbranch_scc1 L1_nopf
    s_getpc_b64 s[4:5]
L1_pc:
    s_sub_u32 s4, s4, L1_pc - parallel_sum__mha_block__dense_activation_squared_relu__prompt_kernel
    s_subb_u32 s5, s5, 0
    s_lshl_b32 s6, s6, 10
    s_add_u32 s4, s4, s6
    s_addc_u32 s5, s5, 0
    global_load_dwordx4 v[8:11], v250, s[4:5]
L1_nopf:
    v_and_b32 v184, 63, v0
    s_mul_i32 s63, s35, 3
    s_add_u32 s63, s63, s37
    s_cmp_ge_u32 s63, 32
    s_cselect_b32 s36, 2, 1
    s_mov_b32 s44, s18
    s_mov_b32 s45, s19
    s_mov_b32 s46, 1204224
    s_mov_b32 s47, 0x20000
    s_mul_i32 s12, s63, 56
    s_and_b32 s65, s12, 15
    s_sub_u32 s57, s12, s65
    s_movk_i32 s13, 2688
L1_p1_go:
    s_lshl_b32 s62, s13, 4
    v_lshrrev_b32 v176, 6, v250
    v_mul_lo_u32 v176, v176, s13
    v_and_b32 v177, 48, v250
    v_add_u32 v165, v176, v177
    s_mov_b32 s68, s36
    s_mov_b32 s69, s63
    s_lshl_b32 s58, s37, 13
    s_add_u32 s58, s58, 114688
    s_add_u32 s81, s60, s37
    s_cmp_eq_u32 s37, 3
    s_cselect_b32 s46, 0, s46
    s_cselect_b32 s68, 0, s68
    s_cselect_b32 s65, 0, s65
    s_mov_b32 s52, s26
    s_mov_b32 s53, s27
    s_mov_b32 s54, 3584
    s_mov_b32 s55, 0x20000
    s_lshl_b32 s12, s81, 6
    v_bfe_u32 v176, v0, 5, 1
    v_lshlrev_b32 v176, 3, v176
    buffer_load_dwordx2 v[208:209], v176, s[52:55], s12 offen offset:0
    buffer_load_dwordx2 v[210:211], v176, s[52:55], s12 offen offset:16
    buffer_load_dwordx2 v[212:213], v176, s[52:55], s12 offen offset:32
    buffer_load_dwordx2 v[214:215], v176, s[52:55], s12 offen offset:48
    s_add_u32 m0, s58, 0
    s_nop 0
    buffer_load_dwordx4 v165, s[44:47], s57 offen lds
    s_add_u32 s57, s57, s62
    s_add_u32 m0, s58, 1024
    s_nop 0
    buffer_load_dwordx4 v165, s[44:47], s57 offen lds
    s_add_u32 s57, s57, s62
    s_mov_b32 s40, s18
    s_mov_b32 s41, s19
    s_mov_b32 s42, 1204224
    s_mov_b32 s43, 0x20000
    s_cmp_lt_u32 s2, 147
    s_cselect_b32 s42, s42, 0
    s_cselect_b32 s12, s2, 0
    s_lshl_b32 s12, s12, 13
    s_lshl_b32 s13, s37, 11
    s_add_u32 s12, s12, s13
    buffer_load_dwordx4 v[8:11], v250, s[40:43], s12 offen
    buffer_load_dwordx4 v[8:11], v250, s[40:43], s12 offen offset:1024
    s_lshl_b32 s12, s37, 2
    s_add_u32 s12, s12, 163440
    v_mov_b32 v186, s12
    s_mov_b32 s13, 1048576
L1_ls1:
    ds_read_b32 v187, v186
    s_waitcnt lgkmcnt(0)
    v_readfirstlane_b32 s12, v187
    s_nop 3
    s_cmp_ge_u32 s12, 1
    s_cbranch_scc1 L1_ls1x
    s_sleep 1
    s_sub_u32 s13, s13, 1
    s_cmp_lg_u32 s13, 0
    s_cbranch_scc1 L1_ls1
L1_ls1x:
    s_add_u32 m0, s58, 2048
    s_nop 0
    buffer_load_dwordx4 v165, s[44:47], s57 offen lds
    s_add_u32 s57, s57, s62
    s_add_u32 m0, s58, 3072
    s_nop 0
    buffer_load_dwordx4 v165, s[44:47], s57 offen lds
    s_add_u32 s57, s57, s62
    s_add_u32 m0, s58, 4096
    s_nop 0
    buffer_load_dwordx4 v165, s[44:47], s57 offen lds
    s_add_u32 s57, s57, s62
    s_add_u32 m0, s58, 5120
    s_nop 0
    buffer_load_dwordx4 v165, s[44:47], s57 offen lds
    s_add_u32 s57, s57, s62
    s_add_u32 m0, s58, 6144
    s_nop 0
    buffer_load_dwordx4 v165, s[44:47], s57 offen lds
    s_add_u32 s57, s57, s62
    s_add_u32 m0, s58, 7168
    s_nop 0
    buffer_load_dwordx4 v165, s[44:47], s57 offen lds
    s_add_u32 s57, s57, s62
    v_lshrrev_b32 v177, 5, v184
    v_lshlrev_b32 v177, 5, v177
    v_bfe_u32 v178, v184, 4, 1
    v_add_u32 v177, v177, v178
    v_and_b32 v178, 15, v184
    v_lshlrev_b32 v178, 4, v178
    v_mul_u32_u24 v179, 2688, v177
    v_add_u32 v179, v179, v178
    s_and_b32 s12, s34, 3
    s_lshl_b32 s12, s12, 2
    s_add_u32 s12, s12, s37
    s_lshl_b32 s12, s12, 1
    s_add_u32 s14, s12, 128
    s_mul_i32 s76, s14, 2688
    s_mul_i32 s14, s35, 168
    s_and_b32 s14, s14, -16
    s_add_u32 s76, s76, s14
    s_mov_b32 s40, s18
    s_mov_b32 s41, s19
    s_mov_b32 s42, 1204224
    s_mov_b32 s43, 0x20000
    buffer_load_dwordx4 v[8:11], v179, s[40:43], s76 offen
    s_add_u32 s76, s76, 172032
    buffer_load_dwordx4 v[8:11], v179, s[40:43], s76 offen
    s_add_u32 s76, s76, 172032
    buffer_load_dwordx4 v[8:11], v179, s[40:43], s76 offen
    s_add_u32 s76, s76, 172032
    buffer_load_dwordx4 v[8:11], v179, s[40:43], s76 offen
    s_add_u32 s76, s76, 172032
    buffer_load_dwordx4 v[8:11], v179, s[40:43], s76 offen
    s_add_u32 s76, s76, 172032
    s_mov_b32 s40, s24
    s_mov_b32 s41, s25
    s_mov_b32 s42, 1605632
    s_mov_b32 s43, 0x20000
    s_cmp_lt_u32 s2, 196
    s_cselect_b32 s42, s42, 0
    s_cselect_b32 s12, s2, 0
    s_lshl_b32 s12, s12, 13
    s_lshl_b32 s13, s37, 11
    s_add_u32 s12, s12, s13
    buffer_load_dwordx4 v[8:11], v250, s[40:43], s12 offen
    buffer_load_dwordx4 v[8:11], v250, s[40:43], s12 offen offset:1024
    v_lshrrev_b32 v177, 5, v184
    v_lshlrev_b32 v177, 3, v177
    v_bfe_u32 v178, v184, 2, 2
    v_add_u32 v177, v177, v178
    v_lshlrev_b32 v177, 6, v177
    v_bfe_u32 v178, v184, 4, 1
    v_lshlrev_b32 v178, 5, v178
    v_add_u32 v177, v177, v178
    v_and_b32 v178, 3, v184
    v_lshlrev_b32 v178, 3, v178
    v_add_u32 v177, v177, v178
    v_and_b32 v179, 19, v184
    v_cmp_eq_u32 vcc, 19, v179
    s_cmp_lg_u32 s68, 0
    s_cselect_b32 s13, 8, 0
    v_mov_b32 v180, 0
    v_mov_b32 v181, s13
    v_cndmask_b32 v180, v180, v181, vcc
    v_sub_u32 v247, s65, v180
    v_add_u32 v177, v177, v247
    v_add_u32 v160, s58, v177
    v_lshrrev_b32 v185, 5, v184
    v_and_b32 v186, 31, v184
    v_bfe_u32 v187, v186, 1, 3
    v_lshlrev_b32 v188, 7, v186
    v_add_u32 v189, 0, v185
    v_xor_b32 v189, v189, v187
    v_lshlrev_b32 v189, 4, v189
    v_add_u32 v161, v188, v189
    v_add_u32 v189, 2, v185
    v_xor_b32 v189, v189, v187
    v_lshlrev_b32 v189, 4, v189
    v_add_u32 v162, v188, v189
    v_add_u32 v189, 4, v185
    v_xor_b32 v189, v189, v187
    v_lshlrev_b32 v189, 4, v189
    v_add_u32 v163, v188, v189
    v_add_u32 v189, 6, v185
    v_xor_b32 v189, v189, v187
    v_lshlrev_b32 v189, 4, v189
    v_add_u32 v164, v188, v189
    v_mov_b32 v172, 163360
    s_mov_b32 s59, 0
    s_mov_b32 s64, 0
    s_mov_b32 s66, 0
    s_mov_b32 s67, 16384
    s_mov_b32 s71, 16384
    s_mov_b32 s70, 4294868992
    v_mov_b32 v16, 0
    v_mov_b32 v17, 0
    v_mov_b32 v18, 0
    v_mov_b32 v19, 0
    v_mov_b32 v20, 0
    v_mov_b32 v21, 0
    v_mov_b32 v22, 0
    v_mov_b32 v23, 0
    v_mov_b32 v24, 0
    v_mov_b32 v25, 0
    v_mov_b32 v26, 0
    v_mov_b32 v27, 0
    v_mov_b32 v28, 0
    v_mov_b32 v29, 0
    v_mov_b32 v30, 0
    v_mov_b32 v31, 0
    v_mov_b32 v32, 0
    v_mov_b32 v33, 0
    v_mov_b32 v34, 0
    v_mov_b32 v35, 0
    v_mov_b32 v36, 0
    v_mov_b32 v37, 0
    v_mov_b32 v38, 0
    v_mov_b32 v39, 0
    v_mov_b32 v40, 0
    v_mov_b32 v41, 0
    v_mov_b32 v42, 0
    v_mov_b32 v43, 0
    v_mov_b32 v44, 0
    v_mov_b32 v45, 0
    v_mov_b32 v46, 0
    v_mov_b32 v47, 0
    v_mov_b32 v48, 0
    v_mov_b32 v49, 0
    v_mov_b32 v50, 0
    v_mov_b32 v51, 0
    v_mov_b32 v52, 0
    v_mov_b32 v53, 0
    v_mov_b32 v54, 0
    v_mov_b32 v55, 0
    v_mov_b32 v56, 0
    v_mov_b32 v57, 0
    v_mov_b32 v58, 0
    v_mov_b32 v59, 0
    v_mov_b32 v60, 0
    v_mov_b32 v61, 0
    v_mov_b32 v62, 0
    v_mov_b32 v63, 0
    v_mov_b32 v64, 0
    v_mov_b32 v65, 0
    v_mov_b32 v66, 0
    v_mov_b32 v67, 0
    v_mov_b32 v68, 0
    v_mov_b32 v69, 0
    v_mov_b32 v70, 0
    v_mov_b32 v71, 0
    v_mov_b32 v72, 0
    v_mov_b32 v73, 0
    v_mov_b32 v74, 0
    v_mov_b32 v75, 0
    v_mov_b32 v76, 0
    v_mov_b32 v77, 0
    v_mov_b32 v78, 0
    v_mov_b32 v79, 0
    v_mov_b32 v218, 0
    v_mov_b32 v219, 0
    v_mov_b32 v220, 0
    v_mov_b32 v221, 0
    v_and_b32 v177, 15, v184
    v_bfe_u32 v178, v184, 4, 1
    v_cmp_eq_u32 vcc, v177, v178
    v_mov_b32 v179, 0
    v_mov_b32 v180, 0x3f803f80
    v_cndmask_b32 v222, v179, v180, vcc
    v_mov_b32 v223, v222
    v_mov_b32 v224, v222
    v_mov_b32 v225, v222
    s_waitcnt vmcnt(17)
    v_lshlrev_b32 v192, 16, v208
    v_and_b32 v193, s92, v208
    v_lshlrev_b32 v194, 16, v209
    v_and_b32 v195, s92, v209
    v_lshlrev_b32 v196, 16, v210
    v_and_b32 v197, s92, v210
    v_lshlrev_b32 v198, 16, v211
    v_and_b32 v199, s92, v211
    v_lshlrev_b32 v200, 16, v212
    v_and_b32 v201, s92, v212
    v_lshlrev_b32 v202, 16, v213
    v_and_b32 v203, s92, v213
    v_lshlrev_b32 v204, 16, v214
    v_and_b32 v205, s92, v214
    v_lshlrev_b32 v206, 16, v215
    v_and_b32 v207, s92, v215
    v_mov_b32 v186, 163476
    s_mov_b32 s78, 1048576
L1_x0:
    ds_read_b128 v[168:171], v186
    s_waitcnt lgkmcnt(0)
    v_min_u32 v168, v168, v169
    v_min3_u32 v168, v168, v170, v171
    s_nop 0
    v_readfirstlane_b32 s76, v168
    s_nop 3
    s_cmp_ge_u32 s76, 1
    s_cbranch_scc1 L1_x0x
    s_sleep 1
    s_sub_u32 s78, s78, 1
    s_cmp_lg_u32 s78, 0
    s_cbranch_scc1 L1_x0
L1_x0x:
    s_waitcnt vmcnt(15)
    ds_read_b128 v[96:99], v161 offset:0
    ds_read_b128 v[100:103], v161 offset:4096
    ds_read_b128 v[104:107], v161 offset:8192
    ds_read_b128 v[108:111], v161 offset:12288
    ds_read_b64_tr_b16 v[80:81], v160 offset:0
    ds_read_b64_tr_b16 v[82:83], v160 offset:256
    ds_read_b128 v[112:115], v162 offset:0
    ds_read_b128 v[116:119], v162 offset:4096
    ds_read_b128 v[120:123], v162 offset:8192
    ds_read_b128 v[124:127], v162 offset:12288
    ds_read_b64_tr_b16 v[84:85], v160 offset:1024
    ds_read_b64_tr_b16 v[86:87], v160 offset:1280
    s_waitcnt lgkmcnt(0)
    s_cmp_eq_u32 s37, 3
    s_cbranch_scc1 L1_w3
    s_cmp_eq_u32 s68, 2
    s_cbranch_scc1 L1_goN
    s_waitcnt vmcnt(12) lgkmcnt(6)
    v_mfma_f32_32x32x16_bf16 v[16:31], v[80:83], v[96:99], v[16:31]
    ds_read_b64_tr_b16 v[88:89], v160 offset:2048
    ds_read_b128 v[128:131], v163 offset:0
    v_mfma_f32_32x32x16_bf16 v[32:47], v[80:83], v[100:103], v[32:47]
    v_mfma_f32_16x16x32_bf16 v[218:221], v[80:83], v[222:225], v[218:221]
    ds_read_b64_tr_b16 v[90:91], v160 offset:2304
    ds_read_b128 v[132:135], v163 offset:4096
    v_mfma_f32_32x32x16_bf16 v[48:63], v[80:83], v[104:107], v[48:63]
    ds_read_b128 v[136:139], v163 offset:8192
    s_add_u32 m0, s58, 0
    s_nop 0
    v_mfma_f32_32x32x16_bf16 v[64:79], v[80:83], v[108:111], v[64:79]
    ds_read_b128 v[140:143], v163 offset:12288
    buffer_load_dwordx4 v165, s[44:47], s57 offen lds
    s_add_u32 s57, s57, s62
    s_waitcnt vmcnt(12) lgkmcnt(6)
    v_mfma_f32_32x32x16_bf16 v[16:31], v[84:87], v[112:115], v[16:31]
    ds_read_b64_tr_b16 v[92:93], v160 offset:3072
    ds_read_b128 v[144:147], v164 offset:0
    v_mfma_f32_32x32x16_bf16 v[32:47], v[84:87], v[116:119], v[32:47]
    v_mfma_f32_16x16x32_bf16 v[218:221], v[84:87], v[222:225], v[218:221]
    ds_read_b64_tr_b16 v[94:95], v160 offset:3328
    ds_read_b128 v[148:151], v164 offset:4096
    v_mfma_f32_32x32x16_bf16 v[48:63], v[84:87], v[120:123], v[48:63]
    ds_read_b128 v[152:155], v164 offset:8192
    s_add_u32 m0, s58, 1024
    s_nop 0
    v_mfma_f32_32x32x16_bf16 v[64:79], v[84:87], v[124:127], v[64:79]
    ds_read_b128 v[156:159], v164 offset:12288
    buffer_load_dwordx4 v165, s[44:47], s57 offen lds
    s_add_u32 s57, s57, s62
    v_xor_b32 v160, 4096, v160
    v_and_b32 v168, s66, v247
    v_sub_u32 v160, v160, v168
    v_add_u32 v161, s67, v161
    v_add_u32 v162, s67, v162
    s_waitcnt vmcnt(12) lgkmcnt(6)
    v_mfma_f32_32x32x16_bf16 v[16:31], v[88:91], v[128:131], v[16:31]
    ds_read_b64_tr_b16 v[80:81], v160 offset:0
    ds_read_b128 v[96:99], v161 offset:0
    v_mfma_f32_32x32x16_bf16 v[32:47], v[88:91], v[132:135], v[32:47]
    v_mfma_f32_16x16x32_bf16 v[218:221], v[88:91], v[222:225], v[218:221]
    ds_read_b64_tr_b16 v[82:83], v160 offset:256
    ds_read_b128 v[100:103], v161 offset:4096
    v_mfma_f32_32x32x16_bf16 v[48:63], v[88:91], v[136:139], v[48:63]
    ds_read_b128 v[104:107], v161 offset:8192
    s_add_u32 m0, s58, 2048
    s_nop 0
    v_mfma_f32_32x32x16_bf16 v[64:79], v[88:91], v[140:143], v[64:79]
    ds_read_b128 v[108:111], v161 offset:12288
    buffer_load_dwordx4 v165, s[44:47], s57 offen lds
    s_add_u32 s57, s57, s62
    v_add_u32 v163, s67, v163
    v_add_u32 v164, s67, v164
    s_waitcnt vmcnt(12) lgkmcnt(6)
    v_mfma_f32_32x32x16_bf16 v[16:31], v[92:95], v[144:147], v[16:31]
    ds_read_b64_tr_b16 v[84:85], v160 offset:1024
    ds_read_b128 v[112:115], v162 offset:0
    v_mfma_f32_32x32x16_bf16 v[32:47], v[92:95], v[148:151], v[32:47]
    v_mfma_f32_16x16x32_bf16 v[218:221], v[92:95], v[222:225], v[218:221]
    ds_read_b64_tr_b16 v[86:87], v160 offset:1280
    ds_read_b128 v[116:119], v162 offset:4096
    v_mfma_f32_32x32x16_bf16 v[48:63], v[92:95], v[152:155], v[48:63]
    ds_read_b128 v[120:123], v162 offset:8192
    s_add_u32 m0, s58, 3072
    s_nop 0
    v_mfma_f32_32x32x16_bf16 v[64:79], v[92:95], v[156:159], v[64:79]
    ds_read_b128 v[124:127], v162 offset:12288
    buffer_load_dwordx4 v165, s[44:47], s57 offen lds
    s_add_u32 s57, s57, s62
    s_xor_b32 s58, s58, 4096
    s_add_u32 s59, s59, 1
    s_cmp_eq_u32 s59, 6
    s_cselect_b32 s66, -1, 0
    s_cselect_b32 s67, s70, s71
    s_cmp_eq_u32 s59, 5
    s_cbranch_scc1 L1_T0a_sw
L1_T0a_ce:
    s_waitcnt vmcnt(12) lgkmcnt(6)
    v_mfma_f32_32x32x16_bf16 v[16:31], v[80:83], v[96:99], v[16:31]
    ds_read_b64_tr_b16 v[88:89], v160 offset:2048
    ds_read_b128 v[128:131], v163 offset:0
    v_mfma_f32_32x32x16_bf16 v[32:47], v[80:83], v[100:103], v[32:47]
    v_mfma_f32_16x16x32_bf16 v[218:221], v[80:83], v[222:225], v[218:221]
    ds_read_b64_tr_b16 v[90:91], v160 offset:2304
    ds_read_b128 v[132:135], v163 offset:4096
    v_mfma_f32_32x32x16_bf16 v[48:63], v[80:83], v[104:107], v[48:63]
    ds_read_b128 v[136:139], v163 offset:8192
    s_add_u32 m0, s58, 0
    s_nop 0
    v_mfma_f32_32x32x16_bf16 v[64:79], v[80:83], v[108:111], v[64:79]
    ds_read_b128 v[140:143], v163 offset:12288
    buffer_load_dwordx4 v165, s[44:47], s57 offen lds
    s_add_u32 s57, s57, s62
    s_waitcnt vmcnt(12) lgkmcnt(6)
    v_mfma_f32_32x32x16_bf16 v[16:31], v[84:87], v[112:115], v[16:31]
    ds_read_b64_tr_b16 v[92:93], v160 offset:3072
    ds_read_b128 v[144:147], v164 offset:0
    v_mfma_f32_32x32x16_bf16 v[32:47], v[84:87], v[116:119], v[32:47]
    v_mfma_f32_16x16x32_bf16 v[218:221], v[84:87], v[222:225], v[218:221]
    ds_read_b64_tr_b16 v[94:95], v160 offset:3328
    ds_read_b128 v[148:151], v164 offset:4096
    v_mfma_f32_32x32x16_bf16 v[48:63], v[84:87], v[120:123], v[48:63]
    ds_read_b128 v[152:155], v164 offset:8192
    s_add_u32 m0, s58, 1024
    s_nop 0
    v_mfma_f32_32x32x16_bf16 v[64:79], v[84:87], v[124:127], v[64:79]
    ds_read_b128 v[156:159], v164 offset:12288
    buffer_load_dwordx4 v165, s[44:47], s57 offen lds
    s_add_u32 s57, s57, s62
    v_xor_b32 v160, 4096, v160
    v_and_b32 v168, s66, v247
    v_sub_u32 v160, v160, v168
    v_add_u32 v161, s67, v161
    v_add_u32 v162, s67, v162
    s_waitcnt vmcnt(5) lgkmcnt(6)
    v_mfma_f32_32x32x16_bf16 v[16:31], v[88:91], v[128:131], v[16:31]
    ds_read_b64_tr_b16 v[80:81], v160 offset:0
    ds_read_b128 v[96:99], v161 offset:0
    v_mfma_f32_32x32x16_bf16 v[32:47], v[88:91], v[132:135], v[32:47]
    v_mfma_f32_16x16x32_bf16 v[218:221], v[88:91], v[222:225], v[218:221]
    ds_read_b64_tr_b16 v[82:83], v160 offset:256
    ds_read_b128 v[100:103], v161 offset:4096
    v_mfma_f32_32x32x16_bf16 v[48:63], v[88:91], v[136:139], v[48:63]
    ds_read_b128 v[104:107], v161 offset:8192
    s_add_u32 m0, s58, 2048
    s_nop 0
    v_mfma_f32_32x32x16_bf16 v[64:79], v[88:91], v[140:143], v[64:79]
    ds_read_b128 v[108:111], v161 offset:12288
    buffer_load_dwordx4 v165, s[44:47], s57 offen lds
    s_add_u32 s57, s57, s62
    v_add_u32 v163, s67, v163
    v_add_u32 v164, s67, v164
    s_waitcnt vmcnt(5) lgkmcnt(6)
    v_mfma_f32_32x32x16_bf16 v[16:31], v[92:95], v[144:147], v[16:31]
    ds_read_b64_tr_b16 v[84:85], v160 offset:1024
    ds_read_b128 v[112:115], v162 offset:0
    v_mfma_f32_32x32x16_bf16 v[32:47], v[92:95], v[148:151], v[32:47]
    v_mfma_f32_16x16x32_bf16 v[218:221], v[92:95], v[222:225], v[218:221]
    ds_read_b64_tr_b16 v[86:87], v160 offset:1280
    ds_read_b128 v[116:119], v162 offset:4096
    v_mfma_f32_32x32x16_bf16 v[48:63], v[92:95], v[152:155], v[48:63]
    ds_read_b128 v[120:123], v162 offset:8192
    s_add_u32 m0, s58, 3072
    s_nop 0
    v_mfma_f32_32x32x16_bf16 v[64:79], v[92:95], v[156:159], v[64:79]
    ds_read_b128 v[124:127], v162 offset:12288
    buffer_load_dwordx4 v165, s[44:47], s57 offen lds
    s_add_u32 s57, s57, s62
    s_lshl_b32 s12, s37, 2
    s_add_u32 s12, s12, 163492
    v_mov_b32 v184, s12
    v_mov_b32 v185, 1
    ds_write_b32 v184, v185
    s_xor_b32 s58, s58, 4096
    s_add_u32 s59, s59, 1
    s_cmp_eq_u32 s59, 6
    s_cselect_b32 s66, -1, 0
    s_cselect_b32 s67, s70, s71
    s_cmp_eq_u32 s59, 5
    s_cbranch_scc1 L1_T0b_sw
L1_T0b_ce:
L1_T0_loop:
    s_waitcnt vmcnt(5) lgkmcnt(6)
    v_mfma_f32_32x32x16_bf16 v[16:31], v[80:83], v[96:99], v[16:31]
    ds_read_b64_tr_b16 v[88:89], v160 offset:2048
    ds_read_b128 v[128:131], v163 offset:0
    v_mfma_f32_32x32x16_bf16 v[32:47], v[80:83], v[100:103], v[32:47]
    v_mfma_f32_16x16x32_bf16 v[218:221], v[80:83], v[222:225], v[218:221]
    ds_read_b64_tr_b16 v[90:91], v160 offset:2304
    ds_read_b128 v[132:135], v163 offset:4096
    v_mfma_f32_32x32x16_bf16 v[48:63], v[80:83], v[104:107], v[48:63]
    ds_read_b128 v[136:139], v163 offset:8192
    s_add_u32 m0, s58, 0
    s_nop 0
    v_mfma_f32_32x32x16_bf16 v[64:79], v[80:83], v[108:111], v[64:79]
    ds_read_b128 v[140:143], v163 offset:12288
    buffer_load_dwordx4 v165, s[44:47], s57 offen lds
    s_add_u32 s57, s57, s62
    s_waitcnt vmcnt(5) lgkmcnt(6)
    v_mfma_f32_32x32x16_bf16 v[16:31], v[84:87], v[112:115], v[16:31]
    ds_read_b64_tr_b16 v[92:93], v160 offset:3072
    ds_read_b128 v[144:147], v164 offset:0
    v_mfma_f32_32x32x16_bf16 v[32:47], v[84:87], v[116:119], v[32:47]
    v_mfma_f32_16x16x32_bf16 v[218:221], v[84:87], v[222:225], v[218:221]
    ds_read_b64_tr_b16 v[94:95], v160 offset:3328
    ds_read_b128 v[148:151], v164 offset:4096
    v_mfma_f32_32x32x16_bf16 v[48:63], v[84:87], v[120:123], v[48:63]
    ds_read_b128 v[152:155], v164 offset:8192
    s_add_u32 m0, s58, 1024
    s_nop 0
    v_mfma_f32_32x32x16_bf16 v[64:79], v[84:87], v[124:127], v[64:79]
    ds_read_b128 v[156:159], v164 offset:12288
    buffer_load_dwordx4 v165, s[44:47], s57 offen lds
    s_add_u32 s57, s57, s62
    v_xor_b32 v160, 4096, v160
    v_and_b32 v168, s66, v247
    v_sub_u32 v160, v160, v168
    v_add_u32 v161, s67, v161
    v_add_u32 v162, s67, v162
    s_waitcnt vmcnt(5) lgkmcnt(6)
    v_mfma_f32_32x32x16_bf16 v[16:31], v[88:91], v[128:131], v[16:31]
    ds_read_b64_tr_b16 v[80:81], v160 offset:0
    ds_read_b128 v[96:99], v161 offset:0
    v_mfma_f32_32x32x16_bf16 v[32:47], v[88:91], v[132:135], v[32:47]
    v_mfma_f32_16x16x32_bf16 v[218:221], v[88:91], v[222:225], v[218:221]
    ds_read_b64_tr_b16 v[82:83], v160 offset:256
    ds_read_b128 v[100:103], v161 offset:4096
    v_mfma_f32_32x32x16_bf16 v[48:63], v[88:91], v[136:139], v[48:63]
    ds_read_b128 v[104:107], v161 offset:8192
    s_add_u32 m0, s58, 2048
    s_nop 0
    v_mfma_f32_32x32x16_bf16 v[64:79], v[88:91], v[140:143], v[64:79]
    ds_read_b128 v[108:111], v161 offset:12288
    buffer_load_dwordx4 v165, s[44:47], s57 offen lds
    s_add_u32 s57, s57, s62
    v_add_u32 v163, s67, v163
    v_add_u32 v164, s67, v164
    s_waitcnt vmcnt(5) lgkmcnt(6)
    v_mfma_f32_32x32x16_bf16 v[16:31], v[92:95], v[144:147], v[16:31]
    ds_read_b64_tr_b16 v[84:85], v160 offset:1024
    ds_read_b128 v[112:115], v162 offset:0
    v_mfma_f32_32x32x16_bf16 v[32:47], v[92:95], v[148:151], v[32:47]
    v_mfma_f32_16x16x32_bf16 v[218:221], v[92:95], v[222:225], v[218:221]
    ds_read_b64_tr_b16 v[86:87], v160 offset:1280
    ds_read_b128 v[116:119], v162 offset:4096
    v_mfma_f32_32x32x16_bf16 v[48:63], v[92:95], v[152:155], v[48:63]
    ds_read_b128 v[120:123], v162 offset:8192
    s_add_u32 m0, s58, 3072
    s_nop 0
    v_mfma_f32_32x32x16_bf16 v[64:79], v[92:95], v[156:159], v[64:79]
    ds_read_b128 v[124:127], v162 offset:12288
    buffer_load_dwordx4 v165, s[44:47], s57 offen lds
    s_add_u32 s57, s57, s62
    s_xor_b32 s58, s58, 4096
    s_add_u32 s59, s59, 1
    s_cmp_eq_u32 s59, 6
    s_cselect_b32 s66, -1, 0
    s_cselect_b32 s67, s70, s71
    s_cmp_eq_u32 s59, 5
    s_cbranch_scc1 L1_T0_sw
L1_T0_ce:
    s_cmp_lt_u32 s59, 7
    s_cbranch_scc1 L1_T0_loop
    v_and_b32 v176, 63, v0
    v_and_b32 v177, 15, v176
    v_lshlrev_b32 v178, 6, v177
    v_lshrrev_b32 v179, 4, v176
    v_lshlrev_b32 v179, 4, v179
    v_add_u32 v178, v178, v179
    s_lshl_b32 s12, s37, 7
    s_add_u32 s12, s12, 148480
    v_add_u32 v178, s12, v178
    v_cmp_gt_u32 vcc, 2, v177
    v_mov_b32 v180, 163424
    s_nop 4
    s_mov_b64 s[14:15], exec
    s_and_b64 exec, exec, vcc
    ds_write_b128 v178, v[218:221]
    s_mov_b64 exec, s[14:15]
    s_mov_b32 s13, 1048576
L1_st1260:
    ds_read_b128 v[168:171], v180
    s_waitcnt lgkmcnt(0)
    v_min_u32 v168, v168, v169
    v_min3_u32 v168, v168, v170, v171
    s_nop 0
    v_readfirstlane_b32 s14, v168
    s_nop 3
    s_cmp_ge_u32 s14, 1
    s_cbranch_scc1 L1_st1260x
    s_sub_u32 s13, s13, 1
    s_cmp_lg_u32 s13, 0
    s_cbranch_scc1 L1_st1260
L1_st1260x:
    v_bfe_u32 v177, v0, 5, 1
    v_lshlrev_b32 v177, 4, v177
    v_and_b32 v179, 31, v0
    v_lshlrev_b32 v179, 2, v179
    v_add_u32 v178, s12, v177
    ds_read_b128 v[226:229], v178 offset:0
    ds_read_b128 v[230:233], v178 offset:32
    ds_read_b128 v[234:237], v178 offset:64
    ds_read_b128 v[238:241], v178 offset:96
    v_add_u32 v181, 147456, v179
    ds_read_b32 v184, v181 offset:0
    ds_read_b32 v188, v181 offset:512
    ds_read_b32 v185, v181 offset:128
    ds_read_b32 v189, v181 offset:640
    ds_read_b32 v186, v181 offset:256
    ds_read_b32 v190, v181 offset:768
    ds_read_b32 v187, v181 offset:384
    ds_read_b32 v191, v181 offset:896
    s_lshl_b32 s78, s34, 13
    s_lshl_b32 s79, s69, 17
    s_add_u32 s78, s78, s79
    s_add_u32 s79, s78, 4096
    s_mov_b32 s85, 0x3e8b97f6
    s_cmp_ge_u32 s69, 16
    s_cselect_b32 s81, 1.0, s85
    s_cselect_b32 s84, 0x3f803f80, 0
    s_mov_b32 s82, 0
    s_mov_b32 s83, -1
    v_mov_b32 v182, s84
    v_lshrrev_b32 v183, 16, v182
    s_waitcnt lgkmcnt(0)
    v_mul_f32 v242, s81, v188
    v_mul_f32 v244, v184, v242
    v_pk_mul_f32 v[16:17], v[16:17], v[242:243] op_sel_hi:[1,0]
    v_pk_mul_f32 v[18:19], v[18:19], v[242:243] op_sel_hi:[1,0]
    v_pk_mul_f32 v[20:21], v[20:21], v[242:243] op_sel_hi:[1,0]
    v_pk_mul_f32 v[22:23], v[22:23], v[242:243] op_sel_hi:[1,0]
    v_pk_mul_f32 v[24:25], v[24:25], v[242:243] op_sel_hi:[1,0]
    v_pk_mul_f32 v[26:27], v[26:27], v[242:243] op_sel_hi:[1,0]
    v_pk_mul_f32 v[28:29], v[28:29], v[242:243] op_sel_hi:[1,0]
    v_pk_mul_f32 v[30:31], v[30:31], v[242:243] op_sel_hi:[1,0]
    v_pk_fma_f32 v[16:17], v[226:227], v[244:245], v[16:17] op_sel_hi:[1,0,1]
    v_pk_fma_f32 v[18:19], v[228:229], v[244:245], v[18:19] op_sel_hi:[1,0,1]
    v_pk_fma_f32 v[20:21], v[230:231], v[244:245], v[20:21] op_sel_hi:[1,0,1]
    v_pk_fma_f32 v[22:23], v[232:233], v[244:245], v[22:23] op_sel_hi:[1,0,1]
    v_pk_fma_f32 v[24:25], v[234:235], v[244:245], v[24:25] op_sel_hi:[1,0,1]
    v_pk_fma_f32 v[26:27], v[236:237], v[244:245], v[26:27] op_sel_hi:[1,0,1]
    v_pk_fma_f32 v[28:29], v[238:239], v[244:245], v[28:29] op_sel_hi:[1,0,1]
    v_pk_fma_f32 v[30:31], v[240:241], v[244:245], v[30:31] op_sel_hi:[1,0,1]
    v_cvt_pk_bf16_f32 v128, v16, v17
    v_cvt_pk_bf16_f32 v129, v18, v19
    v_cvt_pk_bf16_f32 v130, v20, v21
    v_cvt_pk_bf16_f32 v131, v22, v23
    v_cvt_pk_bf16_f32 v132, v24, v25
    v_cvt_pk_bf16_f32 v133, v26, v27
    v_cvt_pk_bf16_f32 v134, v28, v29
    v_cvt_pk_bf16_f32 v135, v30, v31
    v_cndmask_b32 v134, v134, v182, s[82:83]
    v_cndmask_b32 v135, v135, v183, s[82:83]
    buffer_store_dwordx4 v[128:131], v250, s[48:51], s78 offen offset:0 sc1
    buffer_store_dwordx4 v[132:135], v250, s[48:51], s78 offen offset:1024 sc1
    v_mul_f32 v242, s81, v189
    v_mul_f32 v244, v185, v242
    v_pk_mul_f32 v[32:33], v[32:33], v[242:243] op_sel_hi:[1,0]
    v_pk_mul_f32 v[34:35], v[34:35], v[242:243] op_sel_hi:[1,0]
    v_pk_mul_f32 v[36:37], v[36:37], v[242:243] op_sel_hi:[1,0]
    v_pk_mul_f32 v[38:39], v[38:39], v[242:243] op_sel_hi:[1,0]
    v_pk_mul_f32 v[40:41], v[40:41], v[242:243] op_sel_hi:[1,0]
    v_pk_mul_f32 v[42:43], v[42:43], v[242:243] op_sel_hi:[1,0]
    v_pk_mul_f32 v[44:45], v[44:45], v[242:243] op_sel_hi:[1,0]
    v_pk_mul_f32 v[46:47], v[46:47], v[242:243] op_sel_hi:[1,0]
    v_pk_fma_f32 v[32:33], v[226:227], v[244:245], v[32:33] op_sel_hi:[1,0,1]
    v_pk_fma_f32 v[34:35], v[228:229], v[244:245], v[34:35] op_sel_hi:[1,0,1]
    v_pk_fma_f32 v[36:37], v[230:231], v[244:245], v[36:37] op_sel_hi:[1,0,1]
    v_pk_fma_f32 v[38:39], v[232:233], v[244:245], v[38:39] op_sel_hi:[1,0,1]
    v_pk_fma_f32 v[40:41], v[234:235], v[244:245], v[40:41] op_sel_hi:[1,0,1]
    v_pk_fma_f32 v[42:43], v[236:237], v[244:245], v[42:43] op_sel_hi:[1,0,1]
    v_pk_fma_f32 v[44:45], v[238:239], v[244:245], v[44:45] op_sel_hi:[1,0,1]
    v_pk_fma_f32 v[46:47], v[240:241], v[244:245], v[46:47] op_sel_hi:[1,0,1]
    v_cvt_pk_bf16_f32 v136, v32, v33
    v_cvt_pk_bf16_f32 v137, v34, v35
    v_cvt_pk_bf16_f32 v138, v36, v37
    v_cvt_pk_bf16_f32 v139, v38, v39
    v_cvt_pk_bf16_f32 v140, v40, v41
    v_cvt_pk_bf16_f32 v141, v42, v43
    v_cvt_pk_bf16_f32 v142, v44, v45
    v_cvt_pk_bf16_f32 v143, v46, v47
    v_cndmask_b32 v142, v142, v182, s[82:83]
    v_cndmask_b32 v143, v143, v183, s[82:83]
    buffer_store_dwordx4 v[136:139], v250, s[48:51], s78 offen offset:2048 sc1
    buffer_store_dwordx4 v[140:143], v250, s[48:51], s78 offen offset:3072 sc1
    v_mul_f32 v242, s81, v190
    v_mul_f32 v244, v186, v242
    v_pk_mul_f32 v[48:49], v[48:49], v[242:243] op_sel_hi:[1,0]
    v_pk_mul_f32 v[50:51], v[50:51], v[242:243] op_sel_hi:[1,0]
    v_pk_mul_f32 v[52:53], v[52:53], v[242:243] op_sel_hi:[1,0]
    v_pk_mul_f32 v[54:55], v[54:55], v[242:243] op_sel_hi:[1,0]
    v_pk_mul_f32 v[56:57], v[56:57], v[242:243] op_sel_hi:[1,0]
    v_pk_mul_f32 v[58:59], v[58:59], v[242:243] op_sel_hi:[1,0]
    v_pk_mul_f32 v[60:61], v[60:61], v[242:243] op_sel_hi:[1,0]
    v_pk_mul_f32 v[62:63], v[62:63], v[242:243] op_sel_hi:[1,0]
    v_pk_fma_f32 v[48:49], v[226:227], v[244:245], v[48:49] op_sel_hi:[1,0,1]
    v_pk_fma_f32 v[50:51], v[228:229], v[244:245], v[50:51] op_sel_hi:[1,0,1]
    v_pk_fma_f32 v[52:53], v[230:231], v[244:245], v[52:53] op_sel_hi:[1,0,1]
    v_pk_fma_f32 v[54:55], v[232:233], v[244:245], v[54:55] op_sel_hi:[1,0,1]
    v_pk_fma_f32 v[56:57], v[234:235], v[244:245], v[56:57] op_sel_hi:[1,0,1]
    v_pk_fma_f32 v[58:59], v[236:237], v[244:245], v[58:59] op_sel_hi:[1,0,1]
    v_pk_fma_f32 v[60:61], v[238:239], v[244:245], v[60:61] op_sel_hi:[1,0,1]
    v_pk_fma_f32 v[62:63], v[240:241], v[244:245], v[62:63] op_sel_hi:[1,0,1]
    v_cvt_pk_bf16_f32 v144, v48, v49
    v_cvt_pk_bf16_f32 v145, v50, v51
    v_cvt_pk_bf16_f32 v146, v52, v53
    v_cvt_pk_bf16_f32 v147, v54, v55
    v_cvt_pk_bf16_f32 v148, v56, v57
    v_cvt_pk_bf16_f32 v149, v58, v59
    v_cvt_pk_bf16_f32 v150, v60, v61
    v_cvt_pk_bf16_f32 v151, v62, v63
    v_cndmask_b32 v150, v150, v182, s[82:83]
    v_cndmask_b32 v151, v151, v183, s[82:83]
    buffer_store_dwordx4 v[144:147], v250, s[48:51], s79 offen offset:0 sc1
    buffer_store_dwordx4 v[148:151], v250, s[48:51], s79 offen offset:1024 sc1
    v_mul_f32 v242, s81, v191
    v_mul_f32 v244, v187, v242
    v_pk_mul_f32 v[64:65], v[64:65], v[242:243] op_sel_hi:[1,0]
    v_pk_mul_f32 v[66:67], v[66:67], v[242:243] op_sel_hi:[1,0]
    v_pk_mul_f32 v[68:69], v[68:69], v[242:243] op_sel_hi:[1,0]
    v_pk_mul_f32 v[70:71], v[70:71], v[242:243] op_sel_hi:[1,0]
    v_pk_mul_f32 v[72:73], v[72:73], v[242:243] op_sel_hi:[1,0]
    v_pk_mul_f32 v[74:75], v[74:75], v[242:243] op_sel_hi:[1,0]
    v_pk_mul_f32 v[76:77], v[76:77], v[242:243] op_sel_hi:[1,0]
    v_pk_mul_f32 v[78:79], v[78:79], v[242:243] op_sel_hi:[1,0]
    v_pk_fma_f32 v[64:65], v[226:227], v[244:245], v[64:65] op_sel_hi:[1,0,1]
    v_pk_fma_f32 v[66:67], v[228:229], v[244:245], v[66:67] op_sel_hi:[1,0,1]
    v_pk_fma_f32 v[68:69], v[230:231], v[244:245], v[68:69] op_sel_hi:[1,0,1]
    v_pk_fma_f32 v[70:71], v[232:233], v[244:245], v[70:71] op_sel_hi:[1,0,1]
    v_pk_fma_f32 v[72:73], v[234:235], v[244:245], v[72:73] op_sel_hi:[1,0,1]
    v_pk_fma_f32 v[74:75], v[236:237], v[244:245], v[74:75] op_sel_hi:[1,0,1]
    v_pk_fma_f32 v[76:77], v[238:239], v[244:245], v[76:77] op_sel_hi:[1,0,1]
    v_pk_fma_f32 v[78:79], v[240:241], v[244:245], v[78:79] op_sel_hi:[1,0,1]
    v_cvt_pk_bf16_f32 v152, v64, v65
    v_cvt_pk_bf16_f32 v153, v66, v67
    v_cvt_pk_bf16_f32 v154, v68, v69
    v_cvt_pk_bf16_f32 v155, v70, v71
    v_cvt_pk_bf16_f32 v156, v72, v73
    v_cvt_pk_bf16_f32 v157, v74, v75
    v_cvt_pk_bf16_f32 v158, v76, v77
    v_cvt_pk_bf16_f32 v159, v78, v79
    v_cndmask_b32 v158, v158, v182, s[82:83]
    v_cndmask_b32 v159, v159, v183, s[82:83]
    buffer_store_dwordx4 v[152:155], v250, s[48:51], s79 offen offset:2048 sc1
    buffer_store_dwordx4 v[156:159], v250, s[48:51], s79 offen offset:3072 sc1
    s_branch L1_r1
L1_goN:
    s_waitcnt vmcnt(12) lgkmcnt(6)
    v_mfma_f32_32x32x16_bf16 v[16:31], v[96:99], v[80:83], v[16:31]
    ds_read_b64_tr_b16 v[88:89], v160 offset:2048
    ds_read_b128 v[128:131], v163 offset:0
    v_mfma_f32_32x32x16_bf16 v[32:47], v[100:103], v[80:83], v[32:47]
    v_mfma_f32_16x16x32_bf16 v[218:221], v[80:83], v[222:225], v[218:221]
    ds_read_b64_tr_b16 v[90:91], v160 offset:2304
    ds_read_b128 v[132:135], v163 offset:4096
    v_mfma_f32_32x32x16_bf16 v[48:63], v[104:107], v[80:83], v[48:63]
    ds_read_b128 v[136:139], v163 offset:8192
    s_add_u32 m0, s58, 0
    s_nop 0
    v_mfma_f32_32x32x16_bf16 v[64:79], v[108:111], v[80:83], v[64:79]
    ds_read_b128 v[140:143], v163 offset:12288
    buffer_load_dwordx4 v165, s[44:47], s57 offen lds
    s_add_u32 s57, s57, s62
    s_waitcnt vmcnt(12) lgkmcnt(6)
    v_mfma_f32_32x32x16_bf16 v[16:31], v[112:115], v[84:87], v[16:31]
    ds_read_b64_tr_b16 v[92:93], v160 offset:3072
    ds_read_b128 v[144:147], v164 offset:0
    v_mfma_f32_32x32x16_bf16 v[32:47], v[116:119], v[84:87], v[32:47]
    v_mfma_f32_16x16x32_bf16 v[218:221], v[84:87], v[222:225], v[218:221]
    ds_read_b64_tr_b16 v[94:95], v160 offset:3328
    ds_read_b128 v[148:151], v164 offset:4096
    v_mfma_f32_32x32x16_bf16 v[48:63], v[120:123], v[84:87], v[48:63]
    ds_read_b128 v[152:155], v164 offset:8192
    s_add_u32 m0, s58, 1024
    s_nop 0
    v_mfma_f32_32x32x16_bf16 v[64:79], v[124:127], v[84:87], v[64:79]
    ds_read_b128 v[156:159], v164 offset:12288
    buffer_load_dwordx4 v165, s[44:47], s57 offen lds
    s_add_u32 s57, s57, s62
    v_xor_b32 v160, 4096, v160
    v_and_b32 v168, s66, v247
    v_sub_u32 v160, v160, v168
    v_add_u32 v161, s67, v161
    v_add_u32 v162, s67, v162
    s_waitcnt vmcnt(12) lgkmcnt(6)
    v_mfma_f32_32x32x16_bf16 v[16:31], v[128:131], v[88:91], v[16:31]
    ds_read_b64_tr_b16 v[80:81], v160 offset:0
    ds_read_b128 v[96:99], v161 offset:0
    v_mfma_f32_32x32x16_bf16 v[32:47], v[132:135], v[88:91], v[32:47]
    v_mfma_f32_16x16x32_bf16 v[218:221], v[88:91], v[222:225], v[218:221]
    ds_read_b64_tr_b16 v[82:83], v160 offset:256
    ds_read_b128 v[100:103], v161 offset:4096
    v_mfma_f32_32x32x16_bf16 v[48:63], v[136:139], v[88:91], v[48:63]
    ds_read_b128 v[104:107], v161 offset:8192
    s_add_u32 m0, s58, 2048
    s_nop 0
    v_mfma_f32_32x32x16_bf16 v[64:79], v[140:143], v[88:91], v[64:79]
    ds_read_b128 v[108:111], v161 offset:12288
    buffer_load_dwordx4 v165, s[44:47], s57 offen lds
    s_add_u32 s57, s57, s62
    v_add_u32 v163, s67, v163
    v_add_u32 v164, s67, v164
    s_waitcnt vmcnt(12) lgkmcnt(6)
    v_mfma_f32_32x32x16_bf16 v[16:31], v[144:147], v[92:95], v[16:31]
    ds_read_b64_tr_b16 v[84:85], v160 offset:1024
    ds_read_b128 v[112:115], v162 offset:0
    v_mfma_f32_32x32x16_bf16 v[32:47], v[148:151], v[92:95], v[32:47]
    v_mfma_f32_16x16x32_bf16 v[218:221], v[92:95], v[222:225], v[218:221]
    ds_read_b64_tr_b16 v[86:87], v160 offset:1280
    ds_read_b128 v[116:119], v162 offset:4096
    v_mfma_f32_32x32x16_bf16 v[48:63], v[152:155], v[92:95], v[48:63]
    ds_read_b128 v[120:123], v162 offset:8192
    s_add_u32 m0, s58, 3072
    s_nop 0
    v_mfma_f32_32x32x16_bf16 v[64:79], v[156:159], v[92:95], v[64:79]
    ds_read_b128 v[124:127], v162 offset:12288
    buffer_load_dwordx4 v165, s[44:47], s57 offen lds
    s_add_u32 s57, s57, s62
    s_xor_b32 s58, s58, 4096
    s_add_u32 s59, s59, 1
    s_cmp_eq_u32 s59, 6
    s_cselect_b32 s66, -1, 0
    s_cselect_b32 s67, s70, s71
    s_cmp_eq_u32 s59, 5
    s_cbranch_scc1 L1_N0a_sw
L1_N0a_ce:
    s_waitcnt vmcnt(12) lgkmcnt(6)
    v_mfma_f32_32x32x16_bf16 v[16:31], v[96:99], v[80:83], v[16:31]
    ds_read_b64_tr_b16 v[88:89], v160 offset:2048
    ds_read_b128 v[128:131], v163 offset:0
    v_mfma_f32_32x32x16_bf16 v[32:47], v[100:103], v[80:83], v[32:47]
    v_mfma_f32_16x16x32_bf16 v[218:221], v[80:83], v[222:225], v[218:221]
    ds_read_b64_tr_b16 v[90:91], v160 offset:2304
    ds_read_b128 v[132:135], v163 offset:4096
    v_mfma_f32_32x32x16_bf16 v[48:63], v[104:107], v[80:83], v[48:63]
    ds_read_b128 v[136:139], v163 offset:8192
    s_add_u32 m0, s58, 0
    s_nop 0
    v_mfma_f32_32x32x16_bf16 v[64:79], v[108:111], v[80:83], v[64:79]
    ds_read_b128 v[140:143], v163 offset:12288
    buffer_load_dwordx4 v165, s[44:47], s57 offen lds
    s_add_u32 s57, s57, s62
    s_waitcnt vmcnt(12) lgkmcnt(6)
    v_mfma_f32_32x32x16_bf16 v[16:31], v[112:115], v[84:87], v[16:31]
    ds_read_b64_tr_b16 v[92:93], v160 offset:3072
    ds_read_b128 v[144:147], v164 offset:0
    v_mfma_f32_32x32x16_bf16 v[32:47], v[116:119], v[84:87], v[32:47]
    v_mfma_f32_16x16x32_bf16 v[218:221], v[84:87], v[222:225], v[218:221]
    ds_read_b64_tr_b16 v[94:95], v160 offset:3328
    ds_read_b128 v[148:151], v164 offset:4096
    v_mfma_f32_32x32x16_bf16 v[48:63], v[120:123], v[84:87], v[48:63]
    ds_read_b128 v[152:155], v164 offset:8192
    s_add_u32 m0, s58, 1024
    s_nop 0
    v_mfma_f32_32x32x16_bf16 v[64:79], v[124:127], v[84:87], v[64:79]
    ds_read_b128 v[156:159], v164 offset:12288
    buffer_load_dwordx4 v165, s[44:47], s57 offen lds
    s_add_u32 s57, s57, s62
    v_xor_b32 v160, 4096, v160
    v_and_b32 v168, s66, v247
    v_sub_u32 v160, v160, v168
    v_add_u32 v161, s67, v161
    v_add_u32 v162, s67, v162
    s_waitcnt vmcnt(5) lgkmcnt(6)
    v_mfma_f32_32x32x16_bf16 v[16:31], v[128:131], v[88:91], v[16:31]
    ds_read_b64_tr_b16 v[80:81], v160 offset:0
    ds_read_b128 v[96:99], v161 offset:0
    v_mfma_f32_32x32x16_bf16 v[32:47], v[132:135], v[88:91], v[32:47]
    v_mfma_f32_16x16x32_bf16 v[218:221], v[88:91], v[222:225], v[218:221]
    ds_read_b64_tr_b16 v[82:83], v160 offset:256
    ds_read_b128 v[100:103], v161 offset:4096
    v_mfma_f32_32x32x16_bf16 v[48:63], v[136:139], v[88:91], v[48:63]
    ds_read_b128 v[104:107], v161 offset:8192
    s_add_u32 m0, s58, 2048
    s_nop 0
    v_mfma_f32_32x32x16_bf16 v[64:79], v[140:143], v[88:91], v[64:79]
    ds_read_b128 v[108:111], v161 offset:12288
    buffer_load_dwordx4 v165, s[44:47], s57 offen lds
    s_add_u32 s57, s57, s62
    v_add_u32 v163, s67, v163
    v_add_u32 v164, s67, v164
    s_waitcnt vmcnt(5) lgkmcnt(6)
    v_mfma_f32_32x32x16_bf16 v[16:31], v[144:147], v[92:95], v[16:31]
    ds_read_b64_tr_b16 v[84:85], v160 offset:1024
    ds_read_b128 v[112:115], v162 offset:0
    v_mfma_f32_32x32x16_bf16 v[32:47], v[148:151], v[92:95], v[32:47]
    v_mfma_f32_16x16x32_bf16 v[218:221], v[92:95], v[222:225], v[218:221]
    ds_read_b64_tr_b16 v[86:87], v160 offset:1280
    ds_read_b128 v[116:119], v162 offset:4096
    v_mfma_f32_32x32x16_bf16 v[48:63], v[152:155], v[92:95], v[48:63]
    ds_read_b128 v[120:123], v162 offset:8192
    s_add_u32 m0, s58, 3072
    s_nop 0
    v_mfma_f32_32x32x16_bf16 v[64:79], v[156:159], v[92:95], v[64:79]
    ds_read_b128 v[124:127], v162 offset:12288
    buffer_load_dwordx4 v165, s[44:47], s57 offen lds
    s_add_u32 s57, s57, s62
    s_lshl_b32 s12, s37, 2
    s_add_u32 s12, s12, 163492
    v_mov_b32 v184, s12
    v_mov_b32 v185, 1
    ds_write_b32 v184, v185
    s_xor_b32 s58, s58, 4096
    s_add_u32 s59, s59, 1
    s_cmp_eq_u32 s59, 6
    s_cselect_b32 s66, -1, 0
    s_cselect_b32 s67, s70, s71
    s_cmp_eq_u32 s59, 5
    s_cbranch_scc1 L1_N0b_sw
L1_N0b_ce:
L1_N0_loop:
    s_waitcnt vmcnt(5) lgkmcnt(6)
    v_mfma_f32_32x32x16_bf16 v[16:31], v[96:99], v[80:83], v[16:31]
    ds_read_b64_tr_b16 v[88:89], v160 offset:2048
    ds_read_b128 v[128:131], v163 offset:0
    v_mfma_f32_32x32x16_bf16 v[32:47], v[100:103], v[80:83], v[32:47]
    v_mfma_f32_16x16x32_bf16 v[218:221], v[80:83], v[222:225], v[218:221]
    ds_read_b64_tr_b16 v[90:91], v160 offset:2304
    ds_read_b128 v[132:135], v163 offset:4096
    v_mfma_f32_32x32x16_bf16 v[48:63], v[104:107], v[80:83], v[48:63]
    ds_read_b128 v[136:139], v163 offset:8192
    s_add_u32 m0, s58, 0
    s_nop 0
    v_mfma_f32_32x32x16_bf16 v[64:79], v[108:111], v[80:83], v[64:79]
    ds_read_b128 v[140:143], v163 offset:12288
    buffer_load_dwordx4 v165, s[44:47], s57 offen lds
    s_add_u32 s57, s57, s62
    s_waitcnt vmcnt(5) lgkmcnt(6)
    v_mfma_f32_32x32x16_bf16 v[16:31], v[112:115], v[84:87], v[16:31]
    ds_read_b64_tr_b16 v[92:93], v160 offset:3072
    ds_read_b128 v[144:147], v164 offset:0
    v_mfma_f32_32x32x16_bf16 v[32:47], v[116:119], v[84:87], v[32:47]
    v_mfma_f32_16x16x32_bf16 v[218:221], v[84:87], v[222:225], v[218:221]
    ds_read_b64_tr_b16 v[94:95], v160 offset:3328
    ds_read_b128 v[148:151], v164 offset:4096
    v_mfma_f32_32x32x16_bf16 v[48:63], v[120:123], v[84:87], v[48:63]
    ds_read_b128 v[152:155], v164 offset:8192
    s_add_u32 m0, s58, 1024
    s_nop 0
    v_mfma_f32_32x32x16_bf16 v[64:79], v[124:127], v[84:87], v[64:79]
    ds_read_b128 v[156:159], v164 offset:12288
    buffer_load_dwordx4 v165, s[44:47], s57 offen lds
    s_add_u32 s57, s57, s62
    v_xor_b32 v160, 4096, v160
    v_and_b32 v168, s66, v247
    v_sub_u32 v160, v160, v168
    v_add_u32 v161, s67, v161
    v_add_u32 v162, s67, v162
    s_waitcnt vmcnt(5) lgkmcnt(6)
    v_mfma_f32_32x32x16_bf16 v[16:31], v[128:131], v[88:91], v[16:31]
    ds_read_b64_tr_b16 v[80:81], v160 offset:0
    ds_read_b128 v[96:99], v161 offset:0
    v_mfma_f32_32x32x16_bf16 v[32:47], v[132:135], v[88:91], v[32:47]
    v_mfma_f32_16x16x32_bf16 v[218:221], v[88:91], v[222:225], v[218:221]
    ds_read_b64_tr_b16 v[82:83], v160 offset:256
    ds_read_b128 v[100:103], v161 offset:4096
    v_mfma_f32_32x32x16_bf16 v[48:63], v[136:139], v[88:91], v[48:63]
    ds_read_b128 v[104:107], v161 offset:8192
    s_add_u32 m0, s58, 2048
    s_nop 0
    v_mfma_f32_32x32x16_bf16 v[64:79], v[140:143], v[88:91], v[64:79]
    ds_read_b128 v[108:111], v161 offset:12288
    buffer_load_dwordx4 v165, s[44:47], s57 offen lds
    s_add_u32 s57, s57, s62
    v_add_u32 v163, s67, v163
    v_add_u32 v164, s67, v164
    s_waitcnt vmcnt(5) lgkmcnt(6)
    v_mfma_f32_32x32x16_bf16 v[16:31], v[144:147], v[92:95], v[16:31]
    ds_read_b64_tr_b16 v[84:85], v160 offset:1024
    ds_read_b128 v[112:115], v162 offset:0
    v_mfma_f32_32x32x16_bf16 v[32:47], v[148:151], v[92:95], v[32:47]
    v_mfma_f32_16x16x32_bf16 v[218:221], v[92:95], v[222:225], v[218:221]
    ds_read_b64_tr_b16 v[86:87], v160 offset:1280
    ds_read_b128 v[116:119], v162 offset:4096
    v_mfma_f32_32x32x16_bf16 v[48:63], v[152:155], v[92:95], v[48:63]
    ds_read_b128 v[120:123], v162 offset:8192
    s_add_u32 m0, s58, 3072
    s_nop 0
    v_mfma_f32_32x32x16_bf16 v[64:79], v[156:159], v[92:95], v[64:79]
    ds_read_b128 v[124:127], v162 offset:12288
    buffer_load_dwordx4 v165, s[44:47], s57 offen lds
    s_add_u32 s57, s57, s62
    s_xor_b32 s58, s58, 4096
    s_add_u32 s59, s59, 1
    s_cmp_eq_u32 s59, 6
    s_cselect_b32 s66, -1, 0
    s_cselect_b32 s67, s70, s71
    s_cmp_eq_u32 s59, 5
    s_cbranch_scc1 L1_N0_sw
L1_N0_ce:
    s_cmp_lt_u32 s59, 7
    s_cbranch_scc1 L1_N0_loop
    v_and_b32 v176, 63, v0
    v_and_b32 v177, 15, v176
    v_lshlrev_b32 v178, 6, v177
    v_lshrrev_b32 v179, 4, v176
    v_lshlrev_b32 v179, 4, v179
    v_add_u32 v178, v178, v179
    s_lshl_b32 s12, s37, 7
    s_add_u32 s12, s12, 148480
    v_add_u32 v178, s12, v178
    v_cmp_gt_u32 vcc, 2, v177
    v_mov_b32 v180, 163424
    s_nop 4
    s_mov_b64 s[14:15], exec
    s_and_b64 exec, exec, vcc
    ds_write_b128 v178, v[218:221]
    s_mov_b64 exec, s[14:15]
    s_mov_b32 s13, 1048576
L1_st1689:
    ds_read_b128 v[168:171], v180
    s_waitcnt lgkmcnt(0)
    v_min_u32 v168, v168, v169
    v_min3_u32 v168, v168, v170, v171
    s_nop 0
    v_readfirstlane_b32 s14, v168
    s_nop 3
    s_cmp_ge_u32 s14, 1
    s_cbranch_scc1 L1_st1689x
    s_sub_u32 s13, s13, 1
    s_cmp_lg_u32 s13, 0
    s_cbranch_scc1 L1_st1689
L1_st1689x:
    v_bfe_u32 v177, v0, 5, 1
    v_lshlrev_b32 v177, 4, v177
    v_and_b32 v179, 31, v0
    v_lshlrev_b32 v179, 2, v179
    v_add_u32 v178, s12, v179
    ds_read_b32 v242, v178
    v_add_u32 v181, 147456, v177
    v_mov_b32 v246, v181
    s_lshl_b32 s78, s34, 13
    s_lshl_b32 s79, s69, 17
    s_add_u32 s78, s78, s79
    s_add_u32 s79, s78, 4096
    v_and_b32 v244, 31, v0
    v_cmp_le_u32 s[82:83], 28, v244
    v_cmp_eq_u32 vcc, 28, v244
    v_mov_b32 v244, 0
    v_mov_b32 v245, 0x3f803f80
    v_cndmask_b32 v244, v244, v245, vcc
    ds_read_b128 v[226:229], v246 offset:0
    ds_read_b128 v[230:233], v246 offset:32
    ds_read_b128 v[234:237], v246 offset:64
    ds_read_b128 v[238:241], v246 offset:96
    ds_read_b128 v[176:179], v246 offset:512
    ds_read_b128 v[180:183], v246 offset:544
    ds_read_b128 v[184:187], v246 offset:576
    ds_read_b128 v[188:191], v246 offset:608
    s_waitcnt lgkmcnt(0)
    v_pk_fma_f32 v[16:17], v[226:227], v[242:243], v[16:17] op_sel_hi:[1,0,1]
    v_pk_fma_f32 v[18:19], v[228:229], v[242:243], v[18:19] op_sel_hi:[1,0,1]
    v_pk_fma_f32 v[20:21], v[230:231], v[242:243], v[20:21] op_sel_hi:[1,0,1]
    v_pk_fma_f32 v[22:23], v[232:233], v[242:243], v[22:23] op_sel_hi:[1,0,1]
    v_pk_fma_f32 v[24:25], v[234:235], v[242:243], v[24:25] op_sel_hi:[1,0,1]
    v_pk_fma_f32 v[26:27], v[236:237], v[242:243], v[26:27] op_sel_hi:[1,0,1]
    v_pk_fma_f32 v[28:29], v[238:239], v[242:243], v[28:29] op_sel_hi:[1,0,1]
    v_pk_fma_f32 v[30:31], v[240:241], v[242:243], v[30:31] op_sel_hi:[1,0,1]
    v_pk_mul_f32 v[16:17], v[16:17], v[176:177]
    v_pk_mul_f32 v[18:19], v[18:19], v[178:179]
    v_pk_mul_f32 v[20:21], v[20:21], v[180:181]
    v_pk_mul_f32 v[22:23], v[22:23], v[182:183]
    v_pk_mul_f32 v[24:25], v[24:25], v[184:185]
    v_pk_mul_f32 v[26:27], v[26:27], v[186:187]
    v_pk_mul_f32 v[28:29], v[28:29], v[188:189]
    v_pk_mul_f32 v[30:31], v[30:31], v[190:191]
    v_cvt_pk_bf16_f32 v128, v16, v17
    v_cvt_pk_bf16_f32 v129, v18, v19
    v_cvt_pk_bf16_f32 v130, v20, v21
    v_cvt_pk_bf16_f32 v131, v22, v23
    v_cvt_pk_bf16_f32 v132, v24, v25
    v_cvt_pk_bf16_f32 v133, v26, v27
    v_cvt_pk_bf16_f32 v134, v28, v29
    v_cvt_pk_bf16_f32 v135, v30, v31
    v_cndmask_b32 v128, v128, v244, s[82:83]
    v_cndmask_b32 v129, v129, v244, s[82:83]
    v_cndmask_b32 v130, v130, v244, s[82:83]
    v_cndmask_b32 v131, v131, v244, s[82:83]
    v_cndmask_b32 v132, v132, v244, s[82:83]
    v_cndmask_b32 v133, v133, v244, s[82:83]
    v_cndmask_b32 v134, v134, v244, s[82:83]
    v_cndmask_b32 v135, v135, v244, s[82:83]
    buffer_store_dwordx4 v[128:131], v250, s[48:51], s78 offen offset:0 sc1
    buffer_store_dwordx4 v[132:135], v250, s[48:51], s78 offen offset:1024 sc1
    ds_read_b128 v[226:229], v246 offset:128
    ds_read_b128 v[230:233], v246 offset:160
    ds_read_b128 v[234:237], v246 offset:192
    ds_read_b128 v[238:241], v246 offset:224
    ds_read_b128 v[176:179], v246 offset:640
    ds_read_b128 v[180:183], v246 offset:672
    ds_read_b128 v[184:187], v246 offset:704
    ds_read_b128 v[188:191], v246 offset:736
    s_waitcnt lgkmcnt(0)
    v_pk_fma_f32 v[32:33], v[226:227], v[242:243], v[32:33] op_sel_hi:[1,0,1]
    v_pk_fma_f32 v[34:35], v[228:229], v[242:243], v[34:35] op_sel_hi:[1,0,1]
    v_pk_fma_f32 v[36:37], v[230:231], v[242:243], v[36:37] op_sel_hi:[1,0,1]
    v_pk_fma_f32 v[38:39], v[232:233], v[242:243], v[38:39] op_sel_hi:[1,0,1]
    v_pk_fma_f32 v[40:41], v[234:235], v[242:243], v[40:41] op_sel_hi:[1,0,1]
    v_pk_fma_f32 v[42:43], v[236:237], v[242:243], v[42:43] op_sel_hi:[1,0,1]
    v_pk_fma_f32 v[44:45], v[238:239], v[242:243], v[44:45] op_sel_hi:[1,0,1]
    v_pk_fma_f32 v[46:47], v[240:241], v[242:243], v[46:47] op_sel_hi:[1,0,1]
    v_pk_mul_f32 v[32:33], v[32:33], v[176:177]
    v_pk_mul_f32 v[34:35], v[34:35], v[178:179]
    v_pk_mul_f32 v[36:37], v[36:37], v[180:181]
    v_pk_mul_f32 v[38:39], v[38:39], v[182:183]
    v_pk_mul_f32 v[40:41], v[40:41], v[184:185]
    v_pk_mul_f32 v[42:43], v[42:43], v[186:187]
    v_pk_mul_f32 v[44:45], v[44:45], v[188:189]
    v_pk_mul_f32 v[46:47], v[46:47], v[190:191]
    v_cvt_pk_bf16_f32 v136, v32, v33
    v_cvt_pk_bf16_f32 v137, v34, v35
    v_cvt_pk_bf16_f32 v138, v36, v37
    v_cvt_pk_bf16_f32 v139, v38, v39
    v_cvt_pk_bf16_f32 v140, v40, v41
    v_cvt_pk_bf16_f32 v141, v42, v43
    v_cvt_pk_bf16_f32 v142, v44, v45
    v_cvt_pk_bf16_f32 v143, v46, v47
    v_cndmask_b32 v136, v136, v244, s[82:83]
    v_cndmask_b32 v137, v137, v244, s[82:83]
    v_cndmask_b32 v138, v138, v244, s[82:83]
    v_cndmask_b32 v139, v139, v244, s[82:83]
    v_cndmask_b32 v140, v140, v244, s[82:83]
    v_cndmask_b32 v141, v141, v244, s[82:83]
    v_cndmask_b32 v142, v142, v244, s[82:83]
    v_cndmask_b32 v143, v143, v244, s[82:83]
    buffer_store_dwordx4 v[136:139], v250, s[48:51], s78 offen offset:2048 sc1
    buffer_store_dwordx4 v[140:143], v250, s[48:51], s78 offen offset:3072 sc1
    ds_read_b128 v[226:229], v246 offset:256
    ds_read_b128 v[230:233], v246 offset:288
    ds_read_b128 v[234:237], v246 offset:320
    ds_read_b128 v[238:241], v246 offset:352
    ds_read_b128 v[176:179], v246 offset:768
    ds_read_b128 v[180:183], v246 offset:800
    ds_read_b128 v[184:187], v246 offset:832
    ds_read_b128 v[188:191], v246 offset:864
    s_waitcnt lgkmcnt(0)
    v_pk_fma_f32 v[48:49], v[226:227], v[242:243], v[48:49] op_sel_hi:[1,0,1]
    v_pk_fma_f32 v[50:51], v[228:229], v[242:243], v[50:51] op_sel_hi:[1,0,1]
    v_pk_fma_f32 v[52:53], v[230:231], v[242:243], v[52:53] op_sel_hi:[1,0,1]
    v_pk_fma_f32 v[54:55], v[232:233], v[242:243], v[54:55] op_sel_hi:[1,0,1]
    v_pk_fma_f32 v[56:57], v[234:235], v[242:243], v[56:57] op_sel_hi:[1,0,1]
    v_pk_fma_f32 v[58:59], v[236:237], v[242:243], v[58:59] op_sel_hi:[1,0,1]
    v_pk_fma_f32 v[60:61], v[238:239], v[242:243], v[60:61] op_sel_hi:[1,0,1]
    v_pk_fma_f32 v[62:63], v[240:241], v[242:243], v[62:63] op_sel_hi:[1,0,1]
    v_pk_mul_f32 v[48:49], v[48:49], v[176:177]
    v_pk_mul_f32 v[50:51], v[50:51], v[178:179]
    v_pk_mul_f32 v[52:53], v[52:53], v[180:181]
    v_pk_mul_f32 v[54:55], v[54:55], v[182:183]
    v_pk_mul_f32 v[56:57], v[56:57], v[184:185]
    v_pk_mul_f32 v[58:59], v[58:59], v[186:187]
    v_pk_mul_f32 v[60:61], v[60:61], v[188:189]
    v_pk_mul_f32 v[62:63], v[62:63], v[190:191]
    v_cvt_pk_bf16_f32 v144, v48, v49
    v_cvt_pk_bf16_f32 v145, v50, v51
    v_cvt_pk_bf16_f32 v146, v52, v53
    v_cvt_pk_bf16_f32 v147, v54, v55
    v_cvt_pk_bf16_f32 v148, v56, v57
    v_cvt_pk_bf16_f32 v149, v58, v59
    v_cvt_pk_bf16_f32 v150, v60, v61
    v_cvt_pk_bf16_f32 v151, v62, v63
    v_cndmask_b32 v144, v144, v244, s[82:83]
    v_cndmask_b32 v145, v145, v244, s[82:83]
    v_cndmask_b32 v146, v146, v244, s[82:83]
    v_cndmask_b32 v147, v147, v244, s[82:83]
    v_cndmask_b32 v148, v148, v244, s[82:83]
    v_cndmask_b32 v149, v149, v244, s[82:83]
    v_cndmask_b32 v150, v150, v244, s[82:83]
    v_cndmask_b32 v151, v151, v244, s[82:83]
    buffer_store_dwordx4 v[144:147], v250, s[48:51], s79 offen offset:0 sc1
    buffer_store_dwordx4 v[148:151], v250, s[48:51], s79 offen offset:1024 sc1
    ds_read_b128 v[226:229], v246 offset:384
    ds_read_b128 v[230:233], v246 offset:416
    ds_read_b128 v[234:237], v246 offset:448
    ds_read_b128 v[238:241], v246 offset:480
    ds_read_b128 v[176:179], v246 offset:896
    ds_read_b128 v[180:183], v246 offset:928
    ds_read_b128 v[184:187], v246 offset:960
    ds_read_b128 v[188:191], v246 offset:992
    s_waitcnt lgkmcnt(0)
    v_pk_fma_f32 v[64:65], v[226:227], v[242:243], v[64:65] op_sel_hi:[1,0,1]
    v_pk_fma_f32 v[66:67], v[228:229], v[242:243], v[66:67] op_sel_hi:[1,0,1]
    v_pk_fma_f32 v[68:69], v[230:231], v[242:243], v[68:69] op_sel_hi:[1,0,1]
    v_pk_fma_f32 v[70:71], v[232:233], v[242:243], v[70:71] op_sel_hi:[1,0,1]
    v_pk_fma_f32 v[72:73], v[234:235], v[242:243], v[72:73] op_sel_hi:[1,0,1]
    v_pk_fma_f32 v[74:75], v[236:237], v[242:243], v[74:75] op_sel_hi:[1,0,1]
    v_pk_fma_f32 v[76:77], v[238:239], v[242:243], v[76:77] op_sel_hi:[1,0,1]
    v_pk_fma_f32 v[78:79], v[240:241], v[242:243], v[78:79] op_sel_hi:[1,0,1]
    v_pk_mul_f32 v[64:65], v[64:65], v[176:177]
    v_pk_mul_f32 v[66:67], v[66:67], v[178:179]
    v_pk_mul_f32 v[68:69], v[68:69], v[180:181]
    v_pk_mul_f32 v[70:71], v[70:71], v[182:183]
    v_pk_mul_f32 v[72:73], v[72:73], v[184:185]
    v_pk_mul_f32 v[74:75], v[74:75], v[186:187]
    v_pk_mul_f32 v[76:77], v[76:77], v[188:189]
    v_pk_mul_f32 v[78:79], v[78:79], v[190:191]
    v_cvt_pk_bf16_f32 v152, v64, v65
    v_cvt_pk_bf16_f32 v153, v66, v67
    v_cvt_pk_bf16_f32 v154, v68, v69
    v_cvt_pk_bf16_f32 v155, v70, v71
    v_cvt_pk_bf16_f32 v156, v72, v73
    v_cvt_pk_bf16_f32 v157, v74, v75
    v_cvt_pk_bf16_f32 v158, v76, v77
    v_cvt_pk_bf16_f32 v159, v78, v79
    v_cndmask_b32 v152, v152, v244, s[82:83]
    v_cndmask_b32 v153, v153, v244, s[82:83]
    v_cndmask_b32 v154, v154, v244, s[82:83]
    v_cndmask_b32 v155, v155, v244, s[82:83]
    v_cndmask_b32 v156, v156, v244, s[82:83]
    v_cndmask_b32 v157, v157, v244, s[82:83]
    v_cndmask_b32 v158, v158, v244, s[82:83]
    v_cndmask_b32 v159, v159, v244, s[82:83]
    buffer_store_dwordx4 v[152:155], v250, s[48:51], s79 offen offset:2048 sc1
    buffer_store_dwordx4 v[156:159], v250, s[48:51], s79 offen offset:3072 sc1
L1_r1:
    s_cmp_eq_u32 s36, 3
    s_cbranch_scc1 L1_idle
    s_mov_b32 s69, s63
    s_mov_b32 s59, 0
    s_mov_b32 s66, 0
    s_mov_b32 s67, 16384
    s_waitcnt vmcnt(13) lgkmcnt(6)
    v_mfma_f32_32x32x16_bf16 v[16:31], v[80:83], v[96:99], 0
    ds_read_b64_tr_b16 v[88:89], v160 offset:2048
    ds_read_b128 v[128:131], v163 offset:0
    v_mfma_f32_32x32x16_bf16 v[32:47], v[80:83], v[100:103], 0
    v_mfma_f32_16x16x32_bf16 v[218:221], v[80:83], v[222:225], 0
    ds_read_b64_tr_b16 v[90:91], v160 offset:2304
    ds_read_b128 v[132:135], v163 offset:4096
    v_mfma_f32_32x32x16_bf16 v[48:63], v[80:83], v[104:107], 0
    ds_read_b128 v[136:139], v163 offset:8192
    s_add_u32 m0, s58, 0
    s_nop 0
    v_mfma_f32_32x32x16_bf16 v[64:79], v[80:83], v[108:111], 0
    ds_read_b128 v[140:143], v163 offset:12288
    buffer_load_dwordx4 v165, s[44:47], s57 offen lds
    s_add_u32 s57, s57, s62
    s_waitcnt vmcnt(13) lgkmcnt(6)
    v_mfma_f32_32x32x16_bf16 v[16:31], v[84:87], v[112:115], v[16:31]
    ds_read_b64_tr_b16 v[92:93], v160 offset:3072
    ds_read_b128 v[144:147], v164 offset:0
    v_mfma_f32_32x32x16_bf16 v[32:47], v[84:87], v[116:119], v[32:47]
    v_mfma_f32_16x16x32_bf16 v[218:221], v[84:87], v[222:225], v[218:221]
    ds_read_b64_tr_b16 v[94:95], v160 offset:3328
    ds_read_b128 v[148:151], v164 offset:4096
    v_mfma_f32_32x32x16_bf16 v[48:63], v[84:87], v[120:123], v[48:63]
    ds_read_b128 v[152:155], v164 offset:8192
    s_add_u32 m0, s58, 1024
    s_nop 0
    v_mfma_f32_32x32x16_bf16 v[64:79], v[84:87], v[124:127], v[64:79]
    ds_read_b128 v[156:159], v164 offset:12288
    buffer_load_dwordx4 v165, s[44:47], s57 offen lds
    s_add_u32 s57, s57, s62
    v_xor_b32 v160, 4096, v160
    v_and_b32 v168, s66, v247
    v_sub_u32 v160, v160, v168
    v_add_u32 v161, s67, v161
    v_add_u32 v162, s67, v162
    s_waitcnt vmcnt(13) lgkmcnt(6)
    v_mfma_f32_32x32x16_bf16 v[16:31], v[88:91], v[128:131], v[16:31]
    ds_read_b64_tr_b16 v[80:81], v160 offset:0
    ds_read_b128 v[96:99], v161 offset:0
    v_mfma_f32_32x32x16_bf16 v[32:47], v[88:91], v[132:135], v[32:47]
    v_mfma_f32_16x16x32_bf16 v[218:221], v[88:91], v[222:225], v[218:221]
    ds_read_b64_tr_b16 v[82:83], v160 offset:256
    ds_read_b128 v[100:103], v161 offset:4096
    v_mfma_f32_32x32x16_bf16 v[48:63], v[88:91], v[136:139], v[48:63]
    ds_read_b128 v[104:107], v161 offset:8192
    s_add_u32 m0, s58, 2048
    s_nop 0
    v_mfma_f32_32x32x16_bf16 v[64:79], v[88:91], v[140:143], v[64:79]
    ds_read_b128 v[108:111], v161 offset:12288
    buffer_load_dwordx4 v165, s[44:47], s57 offen lds
    s_add_u32 s57, s57, s62
    v_add_u32 v163, s67, v163
    v_add_u32 v164, s67, v164
    s_waitcnt vmcnt(13) lgkmcnt(6)
    v_mfma_f32_32x32x16_bf16 v[16:31], v[92:95], v[144:147], v[16:31]
    ds_read_b64_tr_b16 v[84:85], v160 offset:1024
    ds_read_b128 v[112:115], v162 offset:0
    v_mfma_f32_32x32x16_bf16 v[32:47], v[92:95], v[148:151], v[32:47]
    v_mfma_f32_16x16x32_bf16 v[218:221], v[92:95], v[222:225], v[218:221]
    ds_read_b64_tr_b16 v[86:87], v160 offset:1280
    ds_read_b128 v[116:119], v162 offset:4096
    v_mfma_f32_32x32x16_bf16 v[48:63], v[92:95], v[152:155], v[48:63]
    ds_read_b128 v[120:123], v162 offset:8192
    s_add_u32 m0, s58, 3072
    s_nop 0
    v_mfma_f32_32x32x16_bf16 v[64:79], v[92:95], v[156:159], v[64:79]
    ds_read_b128 v[124:127], v162 offset:12288
    buffer_load_dwordx4 v165, s[44:47], s57 offen lds
    s_add_u32 s57, s57, s62
    s_xor_b32 s58, s58, 4096
    s_add_u32 s59, s59, 1
    s_cmp_ge_u32 s59, 5
    s_cselect_b32 s46, 0, s46
    s_cmp_eq_u32 s59, 3
    s_cbranch_scc1 L1_P0_rdn
L1_P0_ce:
    s_waitcnt vmcnt(13) lgkmcnt(6)
    v_mfma_f32_32x32x16_bf16 v[16:31], v[80:83], v[96:99], v[16:31]
    ds_read_b64_tr_b16 v[88:89], v160 offset:2048
    ds_read_b128 v[128:131], v163 offset:0
    v_mfma_f32_32x32x16_bf16 v[32:47], v[80:83], v[100:103], v[32:47]
    v_mfma_f32_16x16x32_bf16 v[218:221], v[80:83], v[222:225], v[218:221]
    ds_read_b64_tr_b16 v[90:91], v160 offset:2304
    ds_read_b128 v[132:135], v163 offset:4096
    v_mfma_f32_32x32x16_bf16 v[48:63], v[80:83], v[104:107], v[48:63]
    ds_read_b128 v[136:139], v163 offset:8192
    s_add_u32 m0, s58, 0
    s_nop 0
    v_mfma_f32_32x32x16_bf16 v[64:79], v[80:83], v[108:111], v[64:79]
    ds_read_b128 v[140:143], v163 offset:12288
    buffer_load_dwordx4 v165, s[44:47], s57 offen lds
    s_add_u32 s57, s57, s62
    s_waitcnt vmcnt(13) lgkmcnt(6)
    v_mfma_f32_32x32x16_bf16 v[16:31], v[84:87], v[112:115], v[16:31]
    ds_read_b64_tr_b16 v[92:93], v160 offset:3072
    ds_read_b128 v[144:147], v164 offset:0
    v_mfma_f32_32x32x16_bf16 v[32:47], v[84:87], v[116:119], v[32:47]
    v_mfma_f32_16x16x32_bf16 v[218:221], v[84:87], v[222:225], v[218:221]
    ds_read_b64_tr_b16 v[94:95], v160 offset:3328
    ds_read_b128 v[148:151], v164 offset:4096
    v_mfma_f32_32x32x16_bf16 v[48:63], v[84:87], v[120:123], v[48:63]
    ds_read_b128 v[152:155], v164 offset:8192
    s_add_u32 m0, s58, 1024
    s_nop 0
    v_mfma_f32_32x32x16_bf16 v[64:79], v[84:87], v[124:127], v[64:79]
    ds_read_b128 v[156:159], v164 offset:12288
    buffer_load_dwordx4 v165, s[44:47], s57 offen lds
    s_add_u32 s57, s57, s62
    v_xor_b32 v160, 4096, v160
    v_and_b32 v168, s66, v247
    v_sub_u32 v160, v160, v168
    v_add_u32 v161, s67, v161
    v_add_u32 v162, s67, v162
    s_waitcnt vmcnt(5) lgkmcnt(6)
    v_mov_b32 v2, 163456
    s_mov_b32 s13, 1048576
L1_tgA:
    ds_read_b32 v3, v2
    s_waitcnt lgkmcnt(0)
    v_readfirstlane_b32 s100, v3
    s_nop 3
    s_cmp_lg_u32 s100, 0
    s_cbranch_scc1 L1_tgAx
    s_sub_u32 s13, s13, 1
    s_cmp_lg_u32 s13, 0
    s_cbranch_scc1 L1_tgA
L1_tgAx:
    s_lshl_b32 s13, s35, 8
    s_lshl_b32 s14, s34, 2
    s_add_u32 s13, s13, s14
    s_add_u32 s13, s13, 27262976
    v_mov_b32 v2, 163328
    v_mov_b32 v3, 1
    s_mov_b64 exec, 1
    ds_add_rtn_u32 v3, v2, v3
    s_waitcnt lgkmcnt(0)
    s_mov_b64 exec, -1
    v_readfirstlane_b32 s12, v3
    s_nop 3
    s_cmp_lg_u32 s12, 2
    s_cbranch_scc1 LA3x
    v_mov_b32 v2, s100
    v_mov_b32 v3, 0
    s_mov_b64 exec, 1
    buffer_store_dword v2, v3, s[48:51], s13 offen sc1
    s_mov_b64 exec, -1
LA3x:
    v_mfma_f32_32x32x16_bf16 v[16:31], v[88:91], v[128:131], v[16:31]
    ds_read_b64_tr_b16 v[80:81], v160 offset:0
    ds_read_b128 v[96:99], v161 offset:0
    v_mfma_f32_32x32x16_bf16 v[32:47], v[88:91], v[132:135], v[32:47]
    v_mfma_f32_16x16x32_bf16 v[218:221], v[88:91], v[222:225], v[218:221]
    ds_read_b64_tr_b16 v[82:83], v160 offset:256
    ds_read_b128 v[100:103], v161 offset:4096
    v_mfma_f32_32x32x16_bf16 v[48:63], v[88:91], v[136:139], v[48:63]
    ds_read_b128 v[104:107], v161 offset:8192
    s_add_u32 m0, s58, 2048
    s_nop 0
    v_mfma_f32_32x32x16_bf16 v[64:79], v[88:91], v[140:143], v[64:79]
    ds_read_b128 v[108:111], v161 offset:12288
    buffer_load_dwordx4 v165, s[44:47], s57 offen lds
    s_add_u32 s57, s57, s62
    v_add_u32 v163, s67, v163
    v_add_u32 v164, s67, v164
    s_waitcnt vmcnt(5) lgkmcnt(6)
    v_mfma_f32_32x32x16_bf16 v[16:31], v[92:95], v[144:147], v[16:31]
    ds_read_b64_tr_b16 v[84:85], v160 offset:1024
    ds_read_b128 v[112:115], v162 offset:0
    v_mfma_f32_32x32x16_bf16 v[32:47], v[92:95], v[148:151], v[32:47]
    v_mfma_f32_16x16x32_bf16 v[218:221], v[92:95], v[222:225], v[218:221]
    ds_read_b64_tr_b16 v[86:87], v160 offset:1280
    ds_read_b128 v[116:119], v162 offset:4096
    v_mfma_f32_32x32x16_bf16 v[48:63], v[92:95], v[152:155], v[48:63]
    ds_read_b128 v[120:123], v162 offset:8192
    s_add_u32 m0, s58, 3072
    s_nop 0
    v_mfma_f32_32x32x16_bf16 v[64:79], v[92:95], v[156:159], v[64:79]
    ds_read_b128 v[124:127], v162 offset:12288
    buffer_load_dwordx4 v165, s[44:47], s57 offen lds
    s_add_u32 s57, s57, s62
    s_xor_b32 s58, s58, 4096
    s_add_u32 s59, s59, 1
    s_cmp_ge_u32 s59, 5
    s_cselect_b32 s46, 0, s46
    s_cmp_eq_u32 s59, 3
    s_cbranch_scc1 L1_P1_rdn
L1_P1_ce:
L1_T1_loop:
    s_waitcnt vmcnt(5) lgkmcnt(6)
    v_mfma_f32_32x32x16_bf16 v[16:31], v[80:83], v[96:99], v[16:31]
    ds_read_b64_tr_b16 v[88:89], v160 offset:2048
    ds_read_b128 v[128:131], v163 offset:0
    v_mfma_f32_32x32x16_bf16 v[32:47], v[80:83], v[100:103], v[32:47]
    v_mfma_f32_16x16x32_bf16 v[218:221], v[80:83], v[222:225], v[218:221]
    ds_read_b64_tr_b16 v[90:91], v160 offset:2304
    ds_read_b128 v[132:135], v163 offset:4096
    v_mfma_f32_32x32x16_bf16 v[48:63], v[80:83], v[104:107], v[48:63]
    ds_read_b128 v[136:139], v163 offset:8192
    s_add_u32 m0, s58, 0
    s_nop 0
    v_mfma_f32_32x32x16_bf16 v[64:79], v[80:83], v[108:111], v[64:79]
    ds_read_b128 v[140:143], v163 offset:12288
    buffer_load_dwordx4 v165, s[44:47], s57 offen lds
    s_add_u32 s57, s57, s62
    s_waitcnt vmcnt(5) lgkmcnt(6)
    v_mfma_f32_32x32x16_bf16 v[16:31], v[84:87], v[112:115], v[16:31]
    ds_read_b64_tr_b16 v[92:93], v160 offset:3072
    ds_read_b128 v[144:147], v164 offset:0
    v_mfma_f32_32x32x16_bf16 v[32:47], v[84:87], v[116:119], v[32:47]
    v_mfma_f32_16x16x32_bf16 v[218:221], v[84:87], v[222:225], v[218:221]
    ds_read_b64_tr_b16 v[94:95], v160 offset:3328
    ds_read_b128 v[148:151], v164 offset:4096
    v_mfma_f32_32x32x16_bf16 v[48:63], v[84:87], v[120:123], v[48:63]
    ds_read_b128 v[152:155], v164 offset:8192
    s_add_u32 m0, s58, 1024
    s_nop 0
    v_mfma_f32_32x32x16_bf16 v[64:79], v[84:87], v[124:127], v[64:79]
    ds_read_b128 v[156:159], v164 offset:12288
    buffer_load_dwordx4 v165, s[44:47], s57 offen lds
    s_add_u32 s57, s57, s62
    v_xor_b32 v160, 4096, v160
    v_and_b32 v168, s66, v247
    v_sub_u32 v160, v160, v168
    v_add_u32 v161, s67, v161
    v_add_u32 v162, s67, v162
    s_waitcnt vmcnt(5) lgkmcnt(6)
    v_mfma_f32_32x32x16_bf16 v[16:31], v[88:91], v[128:131], v[16:31]
    ds_read_b64_tr_b16 v[80:81], v160 offset:0
    ds_read_b128 v[96:99], v161 offset:0
    v_mfma_f32_32x32x16_bf16 v[32:47], v[88:91], v[132:135], v[32:47]
    v_mfma_f32_16x16x32_bf16 v[218:221], v[88:91], v[222:225], v[218:221]
    ds_read_b64_tr_b16 v[82:83], v160 offset:256
    ds_read_b128 v[100:103], v161 offset:4096
    v_mfma_f32_32x32x16_bf16 v[48:63], v[88:91], v[136:139], v[48:63]
    ds_read_b128 v[104:107], v161 offset:8192
    s_add_u32 m0, s58, 2048
    s_nop 0
    v_mfma_f32_32x32x16_bf16 v[64:79], v[88:91], v[140:143], v[64:79]
    ds_read_b128 v[108:111], v161 offset:12288
    buffer_load_dwordx4 v165, s[44:47], s57 offen lds
    s_add_u32 s57, s57, s62
    v_add_u32 v163, s67, v163
    v_add_u32 v164, s67, v164
    s_waitcnt vmcnt(5) lgkmcnt(6)
    v_mfma_f32_32x32x16_bf16 v[16:31], v[92:95], v[144:147], v[16:31]
    ds_read_b64_tr_b16 v[84:85], v160 offset:1024
    ds_read_b128 v[112:115], v162 offset:0
    v_mfma_f32_32x32x16_bf16 v[32:47], v[92:95], v[148:151], v[32:47]
    v_mfma_f32_16x16x32_bf16 v[218:221], v[92:95], v[222:225], v[218:221]
    ds_read_b64_tr_b16 v[86:87], v160 offset:1280
    ds_read_b128 v[116:119], v162 offset:4096
    v_mfma_f32_32x32x16_bf16 v[48:63], v[92:95], v[152:155], v[48:63]
    ds_read_b128 v[120:123], v162 offset:8192
    s_add_u32 m0, s58, 3072
    s_nop 0
    v_mfma_f32_32x32x16_bf16 v[64:79], v[92:95], v[156:159], v[64:79]
    ds_read_b128 v[124:127], v162 offset:12288
    buffer_load_dwordx4 v165, s[44:47], s57 offen lds
    s_add_u32 s57, s57, s62
    s_xor_b32 s58, s58, 4096
    s_add_u32 s59, s59, 1
    s_cmp_ge_u32 s59, 5
    s_cselect_b32 s46, 0, s46
    s_cmp_eq_u32 s59, 3
    s_cbranch_scc1 L1_T1_rdn
L1_T1_ce:
    s_cmp_lt_u32 s59, 7
    s_cbranch_scc1 L1_T1_loop
L1_epiF:
    s_waitcnt vmcnt(0) lgkmcnt(0)
    v_mov_b32 v2, 163356
    v_mov_b32 v3, 1
    s_mov_b64 exec, 1
    ds_add_u32 v2, v3
    s_mov_b64 exec, -1
    s_setprio 2
    v_and_b32 v176, 63, v0
    v_and_b32 v177, 15, v176
    v_lshlrev_b32 v178, 6, v177
    v_lshrrev_b32 v179, 4, v176
    v_lshlrev_b32 v179, 4, v179
    v_add_u32 v178, v178, v179
    s_lshl_b32 s12, s37, 7
    s_add_u32 s12, s12, 148480
    v_add_u32 v178, s12, v178
    v_cmp_gt_u32 vcc, 2, v177
    v_mov_b32 v180, 163424
    s_nop 4
    s_mov_b64 s[14:15], exec
    s_and_b64 exec, exec, vcc
    ds_write_b128 v178, v[218:221]
    s_mov_b64 exec, s[14:15]
    s_mov_b32 s13, 1048576
L1_st2195:
    ds_read_b128 v[168:171], v180
    s_waitcnt lgkmcnt(0)
    v_min_u32 v168, v168, v169
    v_min3_u32 v168, v168, v170, v171
    s_nop 0
    v_readfirstlane_b32 s14, v168
    s_nop 3
    s_cmp_ge_u32 s14, 1
    s_cbranch_scc1 L1_st2195x
    s_sub_u32 s13, s13, 1
    s_cmp_lg_u32 s13, 0
    s_cbranch_scc1 L1_st2195
L1_st2195x:
    v_bfe_u32 v177, v0, 5, 1
    v_lshlrev_b32 v177, 4, v177
    v_and_b32 v179, 31, v0
    v_lshlrev_b32 v179, 2, v179
    v_add_u32 v178, s12, v177
    ds_read_b128 v[226:229], v178 offset:0
    ds_read_b128 v[230:233], v178 offset:32
    ds_read_b128 v[234:237], v178 offset:64
    ds_read_b128 v[238:241], v178 offset:96
    v_add_u32 v181, 147456, v179
    ds_read_b32 v184, v181 offset:0
    ds_read_b32 v188, v181 offset:512
    ds_read_b32 v185, v181 offset:128
    ds_read_b32 v189, v181 offset:640
    ds_read_b32 v186, v181 offset:256
    ds_read_b32 v190, v181 offset:768
    ds_read_b32 v187, v181 offset:384
    ds_read_b32 v191, v181 offset:896
    s_mul_i32 s78, s34, 458752
    s_lshl_b32 s79, s69, 11
    s_add_u32 s78, s78, s79
    s_add_u32 s78, s78, 6291456
    s_waitcnt lgkmcnt(0)
    v_mov_b32 v242, v188
    v_mul_f32 v244, v184, v188
    v_pk_fma_f32 v[16:17], v[16:17], v[242:243], v[192:193] op_sel_hi:[1,0,1]
    v_pk_fma_f32 v[18:19], v[18:19], v[242:243], v[194:195] op_sel_hi:[1,0,1]
    v_pk_fma_f32 v[20:21], v[20:21], v[242:243], v[196:197] op_sel_hi:[1,0,1]
    v_pk_fma_f32 v[22:23], v[22:23], v[242:243], v[198:199] op_sel_hi:[1,0,1]
    v_pk_fma_f32 v[24:25], v[24:25], v[242:243], v[200:201] op_sel_hi:[1,0,1]
    v_pk_fma_f32 v[26:27], v[26:27], v[242:243], v[202:203] op_sel_hi:[1,0,1]
    v_pk_fma_f32 v[28:29], v[28:29], v[242:243], v[204:205] op_sel_hi:[1,0,1]
    v_pk_fma_f32 v[30:31], v[30:31], v[242:243], v[206:207] op_sel_hi:[1,0,1]
    v_pk_fma_f32 v[16:17], v[226:227], v[244:245], v[16:17] op_sel_hi:[1,0,1]
    v_pk_fma_f32 v[18:19], v[228:229], v[244:245], v[18:19] op_sel_hi:[1,0,1]
    v_pk_fma_f32 v[20:21], v[230:231], v[244:245], v[20:21] op_sel_hi:[1,0,1]
    v_pk_fma_f32 v[22:23], v[232:233], v[244:245], v[22:23] op_sel_hi:[1,0,1]
    v_pk_fma_f32 v[24:25], v[234:235], v[244:245], v[24:25] op_sel_hi:[1,0,1]
    v_pk_fma_f32 v[26:27], v[236:237], v[244:245], v[26:27] op_sel_hi:[1,0,1]
    v_pk_fma_f32 v[28:29], v[238:239], v[244:245], v[28:29] op_sel_hi:[1,0,1]
    v_pk_fma_f32 v[30:31], v[240:241], v[244:245], v[30:31] op_sel_hi:[1,0,1]
    v_max_f32 v16, 0, v16
    v_max_f32 v17, 0, v17
    v_max_f32 v18, 0, v18
    v_max_f32 v19, 0, v19
    v_max_f32 v20, 0, v20
    v_max_f32 v21, 0, v21
    v_max_f32 v22, 0, v22
    v_max_f32 v23, 0, v23
    v_max_f32 v24, 0, v24
    v_max_f32 v25, 0, v25
    v_max_f32 v26, 0, v26
    v_max_f32 v27, 0, v27
    v_max_f32 v28, 0, v28
    v_max_f32 v29, 0, v29
    v_max_f32 v30, 0, v30
    v_max_f32 v31, 0, v31
    v_pk_mul_f32 v[16:17], v[16:17], v[16:17]
    v_pk_mul_f32 v[18:19], v[18:19], v[18:19]
    v_pk_mul_f32 v[20:21], v[20:21], v[20:21]
    v_pk_mul_f32 v[22:23], v[22:23], v[22:23]
    v_pk_mul_f32 v[24:25], v[24:25], v[24:25]
    v_pk_mul_f32 v[26:27], v[26:27], v[26:27]
    v_pk_mul_f32 v[28:29], v[28:29], v[28:29]
    v_pk_mul_f32 v[30:31], v[30:31], v[30:31]
    v_cvt_pk_bf16_f32 v128, v16, v17
    v_cvt_pk_bf16_f32 v129, v18, v19
    v_cvt_pk_bf16_f32 v130, v20, v21
    v_cvt_pk_bf16_f32 v131, v22, v23
    v_cvt_pk_bf16_f32 v132, v24, v25
    v_cvt_pk_bf16_f32 v133, v26, v27
    v_cvt_pk_bf16_f32 v134, v28, v29
    v_cvt_pk_bf16_f32 v135, v30, v31
    v_mov_b32 v242, v189
    v_mul_f32 v244, v185, v189
    v_pk_fma_f32 v[32:33], v[32:33], v[242:243], v[192:193] op_sel_hi:[1,0,1]
    v_pk_fma_f32 v[34:35], v[34:35], v[242:243], v[194:195] op_sel_hi:[1,0,1]
    v_pk_fma_f32 v[36:37], v[36:37], v[242:243], v[196:197] op_sel_hi:[1,0,1]
    v_pk_fma_f32 v[38:39], v[38:39], v[242:243], v[198:199] op_sel_hi:[1,0,1]
    v_pk_fma_f32 v[40:41], v[40:41], v[242:243], v[200:201] op_sel_hi:[1,0,1]
    v_pk_fma_f32 v[42:43], v[42:43], v[242:243], v[202:203] op_sel_hi:[1,0,1]
    v_pk_fma_f32 v[44:45], v[44:45], v[242:243], v[204:205] op_sel_hi:[1,0,1]
    v_pk_fma_f32 v[46:47], v[46:47], v[242:243], v[206:207] op_sel_hi:[1,0,1]
    v_pk_fma_f32 v[32:33], v[226:227], v[244:245], v[32:33] op_sel_hi:[1,0,1]
    v_pk_fma_f32 v[34:35], v[228:229], v[244:245], v[34:35] op_sel_hi:[1,0,1]
    v_pk_fma_f32 v[36:37], v[230:231], v[244:245], v[36:37] op_sel_hi:[1,0,1]
    v_pk_fma_f32 v[38:39], v[232:233], v[244:245], v[38:39] op_sel_hi:[1,0,1]
    v_pk_fma_f32 v[40:41], v[234:235], v[244:245], v[40:41] op_sel_hi:[1,0,1]
    v_pk_fma_f32 v[42:43], v[236:237], v[244:245], v[42:43] op_sel_hi:[1,0,1]
    v_pk_fma_f32 v[44:45], v[238:239], v[244:245], v[44:45] op_sel_hi:[1,0,1]
    v_pk_fma_f32 v[46:47], v[240:241], v[244:245], v[46:47] op_sel_hi:[1,0,1]
    v_max_f32 v32, 0, v32
    v_max_f32 v33, 0, v33
    v_max_f32 v34, 0, v34
    v_max_f32 v35, 0, v35
    v_max_f32 v36, 0, v36
    v_max_f32 v37, 0, v37
    v_max_f32 v38, 0, v38
    v_max_f32 v39, 0, v39
    v_max_f32 v40, 0, v40
    v_max_f32 v41, 0, v41
    v_max_f32 v42, 0, v42
    v_max_f32 v43, 0, v43
    v_max_f32 v44, 0, v44
    v_max_f32 v45, 0, v45
    v_max_f32 v46, 0, v46
    v_max_f32 v47, 0, v47
    v_pk_mul_f32 v[32:33], v[32:33], v[32:33]
    v_pk_mul_f32 v[34:35], v[34:35], v[34:35]
    v_pk_mul_f32 v[36:37], v[36:37], v[36:37]
    v_pk_mul_f32 v[38:39], v[38:39], v[38:39]
    v_pk_mul_f32 v[40:41], v[40:41], v[40:41]
    v_pk_mul_f32 v[42:43], v[42:43], v[42:43]
    v_pk_mul_f32 v[44:45], v[44:45], v[44:45]
    v_pk_mul_f32 v[46:47], v[46:47], v[46:47]
    v_cvt_pk_bf16_f32 v136, v32, v33
    v_cvt_pk_bf16_f32 v137, v34, v35
    v_cvt_pk_bf16_f32 v138, v36, v37
    v_cvt_pk_bf16_f32 v139, v38, v39
    v_cvt_pk_bf16_f32 v140, v40, v41
    v_cvt_pk_bf16_f32 v141, v42, v43
    v_cvt_pk_bf16_f32 v142, v44, v45
    v_cvt_pk_bf16_f32 v143, v46, v47
    v_mov_b32 v242, v190
    v_mul_f32 v244, v186, v190
    v_pk_fma_f32 v[48:49], v[48:49], v[242:243], v[192:193] op_sel_hi:[1,0,1]
    v_pk_fma_f32 v[50:51], v[50:51], v[242:243], v[194:195] op_sel_hi:[1,0,1]
    v_pk_fma_f32 v[52:53], v[52:53], v[242:243], v[196:197] op_sel_hi:[1,0,1]
    v_pk_fma_f32 v[54:55], v[54:55], v[242:243], v[198:199] op_sel_hi:[1,0,1]
    v_pk_fma_f32 v[56:57], v[56:57], v[242:243], v[200:201] op_sel_hi:[1,0,1]
    v_pk_fma_f32 v[58:59], v[58:59], v[242:243], v[202:203] op_sel_hi:[1,0,1]
    v_pk_fma_f32 v[60:61], v[60:61], v[242:243], v[204:205] op_sel_hi:[1,0,1]
    v_pk_fma_f32 v[62:63], v[62:63], v[242:243], v[206:207] op_sel_hi:[1,0,1]
    v_pk_fma_f32 v[48:49], v[226:227], v[244:245], v[48:49] op_sel_hi:[1,0,1]
    v_pk_fma_f32 v[50:51], v[228:229], v[244:245], v[50:51] op_sel_hi:[1,0,1]
    v_pk_fma_f32 v[52:53], v[230:231], v[244:245], v[52:53] op_sel_hi:[1,0,1]
    v_pk_fma_f32 v[54:55], v[232:233], v[244:245], v[54:55] op_sel_hi:[1,0,1]
    v_pk_fma_f32 v[56:57], v[234:235], v[244:245], v[56:57] op_sel_hi:[1,0,1]
    v_pk_fma_f32 v[58:59], v[236:237], v[244:245], v[58:59] op_sel_hi:[1,0,1]
    v_pk_fma_f32 v[60:61], v[238:239], v[244:245], v[60:61] op_sel_hi:[1,0,1]
    v_pk_fma_f32 v[62:63], v[240:241], v[244:245], v[62:63] op_sel_hi:[1,0,1]
    v_max_f32 v48, 0, v48
    v_max_f32 v49, 0, v49
    v_max_f32 v50, 0, v50
    v_max_f32 v51, 0, v51
    v_max_f32 v52, 0, v52
    v_max_f32 v53, 0, v53
    v_max_f32 v54, 0, v54
    v_max_f32 v55, 0, v55
    v_max_f32 v56, 0, v56
    v_max_f32 v57, 0, v57
    v_max_f32 v58, 0, v58
    v_max_f32 v59, 0, v59
    v_max_f32 v60, 0, v60
    v_max_f32 v61, 0, v61
    v_max_f32 v62, 0, v62
    v_max_f32 v63, 0, v63
    v_pk_mul_f32 v[48:49], v[48:49], v[48:49]
    v_pk_mul_f32 v[50:51], v[50:51], v[50:51]
    v_pk_mul_f32 v[52:53], v[52:53], v[52:53]
    v_pk_mul_f32 v[54:55], v[54:55], v[54:55]
    v_pk_mul_f32 v[56:57], v[56:57], v[56:57]
    v_pk_mul_f32 v[58:59], v[58:59], v[58:59]
    v_pk_mul_f32 v[60:61], v[60:61], v[60:61]
    v_pk_mul_f32 v[62:63], v[62:63], v[62:63]
    v_cvt_pk_bf16_f32 v144, v48, v49
    v_cvt_pk_bf16_f32 v145, v50, v51
    v_cvt_pk_bf16_f32 v146, v52, v53
    v_cvt_pk_bf16_f32 v147, v54, v55
    v_cvt_pk_bf16_f32 v148, v56, v57
    v_cvt_pk_bf16_f32 v149, v58, v59
    v_cvt_pk_bf16_f32 v150, v60, v61
    v_cvt_pk_bf16_f32 v151, v62, v63
    v_mov_b32 v242, v191
    v_mul_f32 v244, v187, v191
    v_pk_fma_f32 v[64:65], v[64:65], v[242:243], v[192:193] op_sel_hi:[1,0,1]
    v_pk_fma_f32 v[66:67], v[66:67], v[242:243], v[194:195] op_sel_hi:[1,0,1]
    v_pk_fma_f32 v[68:69], v[68:69], v[242:243], v[196:197] op_sel_hi:[1,0,1]
    v_pk_fma_f32 v[70:71], v[70:71], v[242:243], v[198:199] op_sel_hi:[1,0,1]
    v_pk_fma_f32 v[72:73], v[72:73], v[242:243], v[200:201] op_sel_hi:[1,0,1]
    v_pk_fma_f32 v[74:75], v[74:75], v[242:243], v[202:203] op_sel_hi:[1,0,1]
    v_pk_fma_f32 v[76:77], v[76:77], v[242:243], v[204:205] op_sel_hi:[1,0,1]
    v_pk_fma_f32 v[78:79], v[78:79], v[242:243], v[206:207] op_sel_hi:[1,0,1]
    v_pk_fma_f32 v[64:65], v[226:227], v[244:245], v[64:65] op_sel_hi:[1,0,1]
    v_pk_fma_f32 v[66:67], v[228:229], v[244:245], v[66:67] op_sel_hi:[1,0,1]
    v_pk_fma_f32 v[68:69], v[230:231], v[244:245], v[68:69] op_sel_hi:[1,0,1]
    v_pk_fma_f32 v[70:71], v[232:233], v[244:245], v[70:71] op_sel_hi:[1,0,1]
    v_pk_fma_f32 v[72:73], v[234:235], v[244:245], v[72:73] op_sel_hi:[1,0,1]
    v_pk_fma_f32 v[74:75], v[236:237], v[244:245], v[74:75] op_sel_hi:[1,0,1]
    v_pk_fma_f32 v[76:77], v[238:239], v[244:245], v[76:77] op_sel_hi:[1,0,1]
    v_pk_fma_f32 v[78:79], v[240:241], v[244:245], v[78:79] op_sel_hi:[1,0,1]
    v_max_f32 v64, 0, v64
    v_max_f32 v65, 0, v65
    v_max_f32 v66, 0, v66
    v_max_f32 v67, 0, v67
    v_max_f32 v68, 0, v68
    v_max_f32 v69, 0, v69
    v_max_f32 v70, 0, v70
    v_max_f32 v71, 0, v71
    v_max_f32 v72, 0, v72
    v_max_f32 v73, 0, v73
    v_max_f32 v74, 0, v74
    v_max_f32 v75, 0, v75
    v_max_f32 v76, 0, v76
    v_max_f32 v77, 0, v77
    v_max_f32 v78, 0, v78
    v_max_f32 v79, 0, v79
    v_pk_mul_f32 v[64:65], v[64:65], v[64:65]
    v_pk_mul_f32 v[66:67], v[66:67], v[66:67]
    v_pk_mul_f32 v[68:69], v[68:69], v[68:69]
    v_pk_mul_f32 v[70:71], v[70:71], v[70:71]
    v_pk_mul_f32 v[72:73], v[72:73], v[72:73]
    v_pk_mul_f32 v[74:75], v[74:75], v[74:75]
    v_pk_mul_f32 v[76:77], v[76:77], v[76:77]
    v_pk_mul_f32 v[78:79], v[78:79], v[78:79]
    v_cvt_pk_bf16_f32 v152, v64, v65
    v_cvt_pk_bf16_f32 v153, v66, v67
    v_cvt_pk_bf16_f32 v154, v68, v69
    v_cvt_pk_bf16_f32 v155, v70, v71
    v_cvt_pk_bf16_f32 v156, v72, v73
    v_cvt_pk_bf16_f32 v157, v74, v75
    v_cvt_pk_bf16_f32 v158, v76, v77
    v_cvt_pk_bf16_f32 v159, v78, v79
    v_mov_b32 v2, 163512
    s_mov_b32 s12, 1048576
LD4:
    ds_read_b32 v3, v2
    s_waitcnt lgkmcnt(0)
    v_readfirstlane_b32 s13, v3
    s_nop 3
    s_cmp_ge_u32 s13, 4
    s_cbranch_scc1 LD4x
    s_sleep 1
    s_sub_u32 s12, s12, 1
    s_cmp_lg_u32 s12, 0
    s_cbranch_scc1 LD4
LD4x:
    buffer_store_dwordx4 v[128:131], v250, s[48:51], s78 offen sc1
    buffer_store_dwordx4 v[132:135], v250, s[48:51], s78 offen offset:1024 sc1
    s_add_u32 s78, s78, 114688
    buffer_store_dwordx4 v[136:139], v250, s[48:51], s78 offen sc1
    buffer_store_dwordx4 v[140:143], v250, s[48:51], s78 offen offset:1024 sc1
    s_add_u32 s78, s78, 114688
    buffer_store_dwordx4 v[144:147], v250, s[48:51], s78 offen sc1
    buffer_store_dwordx4 v[148:151], v250, s[48:51], s78 offen offset:1024 sc1
    s_add_u32 s78, s78, 114688
    buffer_store_dwordx4 v[152:155], v250, s[48:51], s78 offen sc1
    buffer_store_dwordx4 v[156:159], v250, s[48:51], s78 offen offset:1024 sc1
    s_add_u32 s78, s78, 114688
    s_branch L1_done
L1_w3:
    v_mov_b32 v186, 163508
    s_mov_b32 s13, 1048576
L1_w3w:
    ds_read_b32 v187, v186
    s_waitcnt lgkmcnt(0)
    v_readfirstlane_b32 s12, v187
    s_nop 3
    s_cmp_lg_u32 s12, 0
    s_cbranch_scc1 L1_w3x
    s_sleep 3
    s_sub_u32 s13, s13, 1
    s_cmp_lg_u32 s13, 0
    s_cbranch_scc1 L1_w3w
L1_w3x:
    s_add_u32 s63, s60, s37
    s_mov_b32 s36, 0
    s_mov_b32 s44, s24
    s_mov_b32 s45, s25
    s_mov_b32 s46, 1605632
    s_mov_b32 s47, 0x20000
    s_lshl_b32 s57, s63, 6
    s_movk_i32 s13, 3584
    s_cmp_ge_u32 s37, s61
    s_cselect_b32 s36, 3, s36
    s_cselect_b32 s46, 0, s46
L1_p8_go:
    s_lshl_b32 s62, s13, 4
    v_lshrrev_b32 v176, 6, v250
    v_mul_lo_u32 v176, v176, s13
    v_and_b32 v177, 48, v250
    v_add_u32 v165, v176, v177
    s_cmp_eq_u32 s36, 3
    s_cbranch_scc1 L1_idle3
    s_mov_b32 s69, s63
    s_waitcnt vmcnt(0)
    s_add_u32 m0, s58, 0
    s_nop 0
    buffer_load_dwordx4 v165, s[44:47], s57 offen lds
    s_add_u32 s57, s57, s62
    s_add_u32 m0, s58, 1024
    s_nop 0
    buffer_load_dwordx4 v165, s[44:47], s57 offen lds
    s_add_u32 s57, s57, s62
    s_add_u32 m0, s58, 2048
    s_nop 0
    buffer_load_dwordx4 v165, s[44:47], s57 offen lds
    s_add_u32 s57, s57, s62
    s_add_u32 m0, s58, 3072
    s_nop 0
    buffer_load_dwordx4 v165, s[44:47], s57 offen lds
    s_add_u32 s57, s57, s62
    s_add_u32 m0, s58, 4096
    s_nop 0
    buffer_load_dwordx4 v165, s[44:47], s57 offen lds
    s_add_u32 s57, s57, s62
    s_add_u32 m0, s58, 5120
    s_nop 0
    buffer_load_dwordx4 v165, s[44:47], s57 offen lds
    s_add_u32 s57, s57, s62
    s_add_u32 m0, s58, 6144
    s_nop 0
    buffer_load_dwordx4 v165, s[44:47], s57 offen lds
    s_add_u32 s57, s57, s62
    s_add_u32 m0, s58, 7168
    s_nop 0
    buffer_load_dwordx4 v165, s[44:47], s57 offen lds
    s_add_u32 s57, s57, s62
    s_waitcnt vmcnt(6)
    ds_read_b128 v[96:99], v161 offset:0
    ds_read_b128 v[100:103], v161 offset:4096
    ds_read_b128 v[104:107], v161 offset:8192
    ds_read_b128 v[108:111], v161 offset:12288
    ds_read_b64_tr_b16 v[80:81], v160 offset:0
    ds_read_b64_tr_b16 v[82:83], v160 offset:256
    ds_read_b128 v[112:115], v162 offset:0
    ds_read_b128 v[116:119], v162 offset:4096
    ds_read_b128 v[120:123], v162 offset:8192
    ds_read_b128 v[124:127], v162 offset:12288
    ds_read_b64_tr_b16 v[84:85], v160 offset:1024
    ds_read_b64_tr_b16 v[86:87], v160 offset:1280
    s_waitcnt lgkmcnt(0)
    s_waitcnt vmcnt(5) lgkmcnt(6)
    v_mfma_f32_32x32x16_bf16 v[16:31], v[80:83], v[96:99], 0
    ds_read_b64_tr_b16 v[88:89], v160 offset:2048
    ds_read_b128 v[128:131], v163 offset:0
    v_mfma_f32_32x32x16_bf16 v[32:47], v[80:83], v[100:103], 0
    v_mfma_f32_16x16x32_bf16 v[218:221], v[80:83], v[222:225], 0
    ds_read_b64_tr_b16 v[90:91], v160 offset:2304
    ds_read_b128 v[132:135], v163 offset:4096
    v_mfma_f32_32x32x16_bf16 v[48:63], v[80:83], v[104:107], 0
    ds_read_b128 v[136:139], v163 offset:8192
    s_add_u32 m0, s58, 0
    s_nop 0
    v_mfma_f32_32x32x16_bf16 v[64:79], v[80:83], v[108:111], 0
    ds_read_b128 v[140:143], v163 offset:12288
    buffer_load_dwordx4 v165, s[44:47], s57 offen lds
    s_add_u32 s57, s57, s62
    s_waitcnt vmcnt(5) lgkmcnt(6)
    v_mfma_f32_32x32x16_bf16 v[16:31], v[84:87], v[112:115], v[16:31]
    ds_read_b64_tr_b16 v[92:93], v160 offset:3072
    ds_read_b128 v[144:147], v164 offset:0
    v_mfma_f32_32x32x16_bf16 v[32:47], v[84:87], v[116:119], v[32:47]
    v_mfma_f32_16x16x32_bf16 v[218:221], v[84:87], v[222:225], v[218:221]
    ds_read_b64_tr_b16 v[94:95], v160 offset:3328
    ds_read_b128 v[148:151], v164 offset:4096
    v_mfma_f32_32x32x16_bf16 v[48:63], v[84:87], v[120:123], v[48:63]
    ds_read_b128 v[152:155], v164 offset:8192
    s_add_u32 m0, s58, 1024
    s_nop 0
    v_mfma_f32_32x32x16_bf16 v[64:79], v[84:87], v[124:127], v[64:79]
    ds_read_b128 v[156:159], v164 offset:12288
    buffer_load_dwordx4 v165, s[44:47], s57 offen lds
    s_add_u32 s57, s57, s62
    v_xor_b32 v160, 4096, v160
    v_and_b32 v168, s66, v247
    v_sub_u32 v160, v160, v168
    v_add_u32 v161, s67, v161
    v_add_u32 v162, s67, v162
    s_waitcnt vmcnt(5) lgkmcnt(6)
    v_mfma_f32_32x32x16_bf16 v[16:31], v[88:91], v[128:131], v[16:31]
    ds_read_b64_tr_b16 v[80:81], v160 offset:0
    ds_read_b128 v[96:99], v161 offset:0
    v_mfma_f32_32x32x16_bf16 v[32:47], v[88:91], v[132:135], v[32:47]
    v_mfma_f32_16x16x32_bf16 v[218:221], v[88:91], v[222:225], v[218:221]
    ds_read_b64_tr_b16 v[82:83], v160 offset:256
    ds_read_b128 v[100:103], v161 offset:4096
    v_mfma_f32_32x32x16_bf16 v[48:63], v[88:91], v[136:139], v[48:63]
    ds_read_b128 v[104:107], v161 offset:8192
    s_add_u32 m0, s58, 2048
    s_nop 0
    v_mfma_f32_32x32x16_bf16 v[64:79], v[88:91], v[140:143], v[64:79]
    ds_read_b128 v[108:111], v161 offset:12288
    buffer_load_dwordx4 v165, s[44:47], s57 offen lds
    s_add_u32 s57, s57, s62
    v_add_u32 v163, s67, v163
    v_add_u32 v164, s67, v164
    s_waitcnt vmcnt(5) lgkmcnt(6)
    v_mfma_f32_32x32x16_bf16 v[16:31], v[92:95], v[144:147], v[16:31]
    ds_read_b64_tr_b16 v[84:85], v160 offset:1024
    ds_read_b128 v[112:115], v162 offset:0
    v_mfma_f32_32x32x16_bf16 v[32:47], v[92:95], v[148:151], v[32:47]
    v_mfma_f32_16x16x32_bf16 v[218:221], v[92:95], v[222:225], v[218:221]
    ds_read_b64_tr_b16 v[86:87], v160 offset:1280
    ds_read_b128 v[116:119], v162 offset:4096
    v_mfma_f32_32x32x16_bf16 v[48:63], v[92:95], v[152:155], v[48:63]
    ds_read_b128 v[120:123], v162 offset:8192
    s_add_u32 m0, s58, 3072
    s_nop 0
    v_mfma_f32_32x32x16_bf16 v[64:79], v[92:95], v[156:159], v[64:79]
    ds_read_b128 v[124:127], v162 offset:12288
    buffer_load_dwordx4 v165, s[44:47], s57 offen lds
    s_add_u32 s57, s57, s62
    s_xor_b32 s58, s58, 4096
    s_add_u32 s59, s59, 1
    s_cmp_ge_u32 s59, 5
    s_cselect_b32 s46, 0, s46
    s_cmp_eq_u32 s59, 3
    s_cbranch_scc1 L1_W3_rdn
L1_W3_ce:
    s_branch L1_T1_loop
L1_idle:
    s_waitcnt vmcnt(0) lgkmcnt(0)
    v_mov_b32 v2, 163456
    s_mov_b32 s13, 1048576
L1_tgB:
    ds_read_b32 v3, v2
    s_waitcnt lgkmcnt(0)
    v_readfirstlane_b32 s100, v3
    s_nop 3
    s_cmp_lg_u32 s100, 0
    s_cbranch_scc1 L1_tgBx
    s_sub_u32 s13, s13, 1
    s_cmp_lg_u32 s13, 0
    s_cbranch_scc1 L1_tgB
L1_tgBx:
    s_lshl_b32 s13, s35, 8
    s_lshl_b32 s14, s34, 2
    s_add_u32 s13, s13, s14
    s_add_u32 s13, s13, 27262976
    v_mov_b32 v2, 163328
    v_mov_b32 v3, 1
    s_mov_b64 exec, 1
    ds_add_rtn_u32 v3, v2, v3
    s_waitcnt lgkmcnt(0)
    s_mov_b64 exec, -1
    v_readfirstlane_b32 s12, v3
    s_nop 3
    s_cmp_lg_u32 s12, 2
    s_cbranch_scc1 LA5x
    v_mov_b32 v2, s100
    v_mov_b32 v3, 0
    s_mov_b64 exec, 1
    buffer_store_dword v2, v3, s[48:51], s13 offen sc1
    s_mov_b64 exec, -1
LA5x:
L1_idle3:
    s_waitcnt vmcnt(0) lgkmcnt(0)
    v_mov_b32 v2, 163356
    v_mov_b32 v3, 1
    s_mov_b64 exec, 1
    ds_add_u32 v2, v3
    s_mov_b64 exec, -1
    s_setprio 2
L1_done:
    v_mov_b32 v2, 163456
    s_mov_b32 s13, 1048576
L1_tgC:
    ds_read_b32 v3, v2
    s_waitcnt lgkmcnt(0)
    v_readfirstlane_b32 s100, v3
    s_nop 3
    s_cmp_lg_u32 s100, 0
    s_cbranch_scc1 L1_tgCx
    s_sub_u32 s13, s13, 1
    s_cmp_lg_u32 s13, 0
    s_cbranch_scc1 L1_tgC
L1_tgCx:
    s_lshl_b32 s13, s34, 8
    s_lshl_b32 s14, s35, 2
    s_add_u32 s13, s13, s14
    s_add_u32 s82, s13, 27267072
    s_waitcnt vmcnt(0)
    v_mov_b32 v2, 163348
    v_mov_b32 v3, 1
    s_mov_b64 exec, 1
    ds_add_rtn_u32 v3, v2, v3
    s_waitcnt lgkmcnt(0)
    s_mov_b64 exec, -1
    v_readfirstlane_b32 s12, v3
    s_nop 3
    s_cmp_lg_u32 s12, 3
    s_cbranch_scc1 LA6x
    v_mov_b32 v2, s100
    v_mov_b32 v3, 0
    s_mov_b64 exec, 1
    buffer_store_dword v2, v3, s[48:51], s82 offen sc1
    s_mov_b64 exec, -1
LA6x:
    s_branch L2_ffn_entry
L1_T0a_sw:
    v_mov_b32 v184, 163508
    v_mov_b32 v185, 1
    ds_write_b32 v184, v185
    s_mov_b32 s80, s65
    s_add_u32 s63, s60, s37
    s_mov_b32 s36, 0
    s_mov_b32 s44, s24
    s_mov_b32 s45, s25
    s_mov_b32 s46, 1605632
    s_mov_b32 s47, 0x20000
    s_lshl_b32 s57, s63, 6
    s_movk_i32 s13, 3584
    s_cmp_ge_u32 s37, s61
    s_cselect_b32 s36, 3, s36
    s_cselect_b32 s46, 0, s46
L1_p2_go:
    s_lshl_b32 s62, s13, 4
    v_lshrrev_b32 v176, 6, v250
    v_mul_lo_u32 v176, v176, s13
    v_and_b32 v177, 48, v250
    v_add_u32 v165, v176, v177
    s_mov_b32 s65, s80
    s_branch L1_T0a_ce
L1_T0b_sw:
    v_mov_b32 v184, 163508
    v_mov_b32 v185, 1
    ds_write_b32 v184, v185
    s_mov_b32 s80, s65
    s_add_u32 s63, s60, s37
    s_mov_b32 s36, 0
    s_mov_b32 s44, s24
    s_mov_b32 s45, s25
    s_mov_b32 s46, 1605632
    s_mov_b32 s47, 0x20000
    s_lshl_b32 s57, s63, 6
    s_movk_i32 s13, 3584
    s_cmp_ge_u32 s37, s61
    s_cselect_b32 s36, 3, s36
    s_cselect_b32 s46, 0, s46
L1_p3_go:
    s_lshl_b32 s62, s13, 4
    v_lshrrev_b32 v176, 6, v250
    v_mul_lo_u32 v176, v176, s13
    v_and_b32 v177, 48, v250
    v_add_u32 v165, v176, v177
    s_mov_b32 s65, s80
    s_branch L1_T0b_ce
L1_T0_sw:
    v_mov_b32 v184, 163508
    v_mov_b32 v185, 1
    ds_write_b32 v184, v185
    s_mov_b32 s80, s65
    s_add_u32 s63, s60, s37
    s_mov_b32 s36, 0
    s_mov_b32 s44, s24
    s_mov_b32 s45, s25
    s_mov_b32 s46, 1605632
    s_mov_b32 s47, 0x20000
    s_lshl_b32 s57, s63, 6
    s_movk_i32 s13, 3584
    s_cmp_ge_u32 s37, s61
    s_cselect_b32 s36, 3, s36
    s_cselect_b32 s46, 0, s46
L1_p4_go:
    s_lshl_b32 s62, s13, 4
    v_lshrrev_b32 v176, 6, v250
    v_mul_lo_u32 v176, v176, s13
    v_and_b32 v177, 48, v250
    v_add_u32 v165, v176, v177
    s_mov_b32 s65, s80
    s_branch L1_T0_ce
L1_N0a_sw:
    v_mov_b32 v184, 163508
    v_mov_b32 v185, 1
    ds_write_b32 v184, v185
    s_mov_b32 s80, s65
    s_add_u32 s63, s60, s37
    s_mov_b32 s36, 0
    s_mov_b32 s44, s24
    s_mov_b32 s45, s25
    s_mov_b32 s46, 1605632
    s_mov_b32 s47, 0x20000
    s_lshl_b32 s57, s63, 6
    s_movk_i32 s13, 3584
    s_cmp_ge_u32 s37, s61
    s_cselect_b32 s36, 3, s36
    s_cselect_b32 s46, 0, s46
L1_p5_go:
    s_lshl_b32 s62, s13, 4
    v_lshrrev_b32 v176, 6, v250
    v_mul_lo_u32 v176, v176, s13
    v_and_b32 v177, 48, v250
    v_add_u32 v165, v176, v177
    s_mov_b32 s65, s80
    s_branch L1_N0a_ce
L1_N0b_sw:
    v_mov_b32 v184, 163508
    v_mov_b32 v185, 1
    ds_write_b32 v184, v185
    s_mov_b32 s80, s65
    s_add_u32 s63, s60, s37
    s_mov_b32 s36, 0
    s_mov_b32 s44, s24
    s_mov_b32 s45, s25
    s_mov_b32 s46, 1605632
    s_mov_b32 s47, 0x20000
    s_lshl_b32 s57, s63, 6
    s_movk_i32 s13, 3584
    s_cmp_ge_u32 s37, s61
    s_cselect_b32 s36, 3, s36
    s_cselect_b32 s46, 0, s46
L1_p6_go:
    s_lshl_b32 s62, s13, 4
    v_lshrrev_b32 v176, 6, v250
    v_mul_lo_u32 v176, v176, s13
    v_and_b32 v177, 48, v250
    v_add_u32 v165, v176, v177
    s_mov_b32 s65, s80
    s_branch L1_N0b_ce
L1_N0_sw:
    v_mov_b32 v184, 163508
    v_mov_b32 v185, 1
    ds_write_b32 v184, v185
    s_mov_b32 s80, s65
    s_add_u32 s63, s60, s37
    s_mov_b32 s36, 0
    s_mov_b32 s44, s24
    s_mov_b32 s45, s25
    s_mov_b32 s46, 1605632
    s_mov_b32 s47, 0x20000
    s_lshl_b32 s57, s63, 6
    s_movk_i32 s13, 3584
    s_cmp_ge_u32 s37, s61
    s_cselect_b32 s36, 3, s36
    s_cselect_b32 s46, 0, s46
L1_p7_go:
    s_lshl_b32 s62, s13, 4
    v_lshrrev_b32 v176, 6, v250
    v_mul_lo_u32 v176, v176, s13
    v_and_b32 v177, 48, v250
    v_add_u32 v165, v176, v177
    s_mov_b32 s65, s80
    s_branch L1_N0_ce
L1_P0_rdn:
    s_lshl_b32 s12, s37, 2
    s_add_u32 s12, s12, 163460
    v_mov_b32 v184, s12
    v_mov_b32 v185, 1
    ds_write_b32 v184, v185
    s_branch L1_P0_ce
L1_P1_rdn:
    s_lshl_b32 s12, s37, 2
    s_add_u32 s12, s12, 163460
    v_mov_b32 v184, s12
    v_mov_b32 v185, 1
    ds_write_b32 v184, v185
    s_branch L1_P1_ce
L1_T1_rdn:
    s_lshl_b32 s12, s37, 2
    s_add_u32 s12, s12, 163460
    v_mov_b32 v184, s12
    v_mov_b32 v185, 1
    ds_write_b32 v184, v185
    s_branch L1_T1_ce
L1_W3_rdn:
    s_lshl_b32 s12, s37, 2
    s_add_u32 s12, s12, 163460
    v_mov_b32 v184, s12
    v_mov_b32 v185, 1
    ds_write_b32 v184, v185
    s_branch L1_W3_ce
L1_end:
    s_endpgm
L2_attn_entry:
    s_and_b32 s38, s2, 7
    s_lshr_b32 s39, s2, 3
    s_lshr_b32 s3, s39, 4
    s_lshl_b32 s34, s38, 1
    s_add_u32 s34, s34, s3
    s_and_b32 s35, s39, 15
    v_and_b32 v1, 63, v0
    v_lshlrev_b32 v1, 4, v1
    s_mov_b32 s64, 0
    s_mov_b32 s65, -1
    s_lshl_b32 s70, s34, 6
    s_lshl_b32 s71, s37, 4
    s_add_u32 s70, s70, s71
    s_lshl_b32 s70, s70, 11
    s_add_u32 s71, s70, 2097152
    s_add_u32 s40, s32, s71
    s_addc_u32 s41, s33, 0
    s_mov_b32 s42, 32768
    s_mov_b32 s43, 0x20000
    s_add_u32 s71, s70, 4194304
    s_add_u32 s44, s32, s71
    s_addc_u32 s45, s33, 0
    s_mov_b32 s46, 32768
    s_mov_b32 s47, 0x20000
    s_lshl_b32 s70, s34, 6
    s_lshl_b32 s71, s35, 2
    s_add_u32 s70, s70, s71
    s_lshl_b32 s70, s70, 11
    s_add_u32 s72, s70, 0
    s_add_u32 s73, s72, 4096
    s_lshl_b32 s74, s34, 17
    s_add_u32 s74, s74, 2097152
    v_mov_b32 v16, 0
    v_mov_b32 v17, 0
    v_mov_b32 v18, 0
    v_mov_b32 v19, 0
    v_mov_b32 v20, 0
    v_mov_b32 v21, 0
    v_mov_b32 v22, 0
    v_mov_b32 v23, 0
    v_mov_b32 v24, 0
    v_mov_b32 v25, 0
    v_mov_b32 v26, 0
    v_mov_b32 v27, 0
    v_mov_b32 v28, 0
    v_mov_b32 v29, 0
    v_mov_b32 v30, 0
    v_mov_b32 v31, 0
    v_mov_b32 v32, 0
    v_mov_b32 v33, 0
    v_mov_b32 v34, 0
    v_mov_b32 v35, 0
    v_mov_b32 v36, 0
    v_mov_b32 v37, 0
    v_mov_b32 v38, 0
    v_mov_b32 v39, 0
    v_mov_b32 v40, 0
    v_mov_b32 v41, 0
    v_mov_b32 v42, 0
    v_mov_b32 v43, 0
    v_mov_b32 v44, 0
    v_mov_b32 v45, 0
    v_mov_b32 v46, 0
    v_mov_b32 v47, 0
    v_mov_b32 v48, 0
    v_mov_b32 v49, 0
    v_mov_b32 v50, 0
    v_mov_b32 v51, 0
    v_mov_b32 v52, 0
    v_mov_b32 v53, 0
    v_mov_b32 v54, 0
    v_mov_b32 v55, 0
    v_mov_b32 v56, 0
    v_mov_b32 v57, 0
    v_mov_b32 v58, 0
    v_mov_b32 v59, 0
    v_mov_b32 v60, 0
    v_mov_b32 v61, 0
    v_mov_b32 v62, 0
    v_mov_b32 v63, 0
    v_mov_b32 v2, 163332
    s_mov_b32 s78, 1048576
L2_lw:
    ds_read_b32 v3, v2
    s_waitcnt lgkmcnt(0)
    v_readfirstlane_b32 s79, v3
    s_nop 3
    s_cmp_lg_u32 s79, 0
    s_cbranch_scc1 L2_lx
    s_sleep 3
    s_sub_u32 s78, s78, 1
    s_cmp_lg_u32 s78, 0
    s_cbranch_scc1 L2_lw
L2_lx:
    buffer_load_dwordx4 v[80:83], v1, s[48:51], s72 offen offset:0 sc1
    buffer_load_dwordx4 v[84:87], v1, s[48:51], s72 offen offset:1024 sc1
    buffer_load_dwordx4 v[88:91], v1, s[48:51], s72 offen offset:2048 sc1
    buffer_load_dwordx4 v[92:95], v1, s[48:51], s72 offen offset:3072 sc1
    buffer_load_dwordx4 v[96:99], v1, s[48:51], s73 offen offset:0 sc1
    buffer_load_dwordx4 v[100:103], v1, s[48:51], s73 offen offset:1024 sc1
    buffer_load_dwordx4 v[104:107], v1, s[48:51], s73 offen offset:2048 sc1
    buffer_load_dwordx4 v[108:111], v1, s[48:51], s73 offen offset:3072 sc1
    buffer_load_dwordx4 v[216:219], v1, s[48:51], s74 offen sc1
    buffer_load_dwordx4 v[220:223], v1, s[48:51], s74 offen offset:1024 sc1
    s_mov_b32 s60, 0
    buffer_load_dwordx4 v[112:115], v1, s[40:43], s60 offen sc1
    buffer_load_dwordx4 v[116:119], v1, s[40:43], s60 offen offset:1024 sc1
    s_setprio 1
    s_waitcnt vmcnt(2)
    buffer_load_dwordx4 v[184:187], v1, s[44:47], s60 offen sc1
    buffer_load_dwordx4 v[188:191], v1, s[44:47], s60 offen offset:1024 sc1
    s_add_u32 s60, s60, 2048
    buffer_load_dwordx4 v[120:123], v1, s[40:43], s60 offen sc1
    buffer_load_dwordx4 v[124:127], v1, s[40:43], s60 offen offset:1024 sc1
    buffer_load_dwordx4 v[192:195], v1, s[44:47], s60 offen sc1
    buffer_load_dwordx4 v[196:199], v1, s[44:47], s60 offen offset:1024 sc1
    s_add_u32 s60, s60, 2048
    buffer_load_dwordx4 v[128:131], v1, s[40:43], s60 offen sc1
    buffer_load_dwordx4 v[132:135], v1, s[40:43], s60 offen offset:1024 sc1
    buffer_load_dwordx4 v[200:203], v1, s[44:47], s60 offen sc1
    buffer_load_dwordx4 v[204:207], v1, s[44:47], s60 offen offset:1024 sc1
    s_add_u32 s60, s60, 2048
    buffer_load_dwordx4 v[136:139], v1, s[40:43], s60 offen sc1
    buffer_load_dwordx4 v[140:143], v1, s[40:43], s60 offen offset:1024 sc1
    s_add_u32 s60, s60, 2048
    v_mov_b32 v2, 163512
    v_mov_b32 v3, 1
    s_mov_b64 exec, 1
    ds_add_u32 v2, v3
    s_mov_b64 exec, -1
    s_mov_b32 s61, 6144
    s_mov_b32 s62, 0
    v_mfma_f32_32x32x16_bf16 v[144:159], v[216:219], v[80:83], 0
    v_mfma_f32_32x32x16_bf16 v[160:175], v[216:219], v[88:91], 0
    v_mfma_f32_32x32x16_bf16 v[224:239], v[216:219], v[96:99], 0
    v_mfma_f32_32x32x16_bf16 v[64:79], v[216:219], v[104:107], 0
    v_mfma_f32_32x32x16_bf16 v[144:159], v[220:223], v[84:87], v[144:159]
    v_mfma_f32_32x32x16_bf16 v[160:175], v[220:223], v[92:95], v[160:175]
    v_mfma_f32_32x32x16_bf16 v[224:239], v[220:223], v[100:103], v[224:239]
    v_mfma_f32_32x32x16_bf16 v[64:79], v[220:223], v[108:111], v[64:79]
    s_nop 8
    v_max3_f32 v248, v144, v145, v146
    v_max3_f32 v248, v248, v147, v148
    v_max3_f32 v248, v248, v149, v150
    v_max3_f32 v248, v248, v151, v152
    v_max3_f32 v248, v248, v153, v154
    v_max3_f32 v248, v248, v155, v156
    v_max3_f32 v248, v248, v157, v158
    v_max_f32 v248, v248, v159
    v_max3_f32 v249, v160, v161, v162
    v_max3_f32 v249, v249, v163, v164
    v_max3_f32 v249, v249, v165, v166
    v_max3_f32 v249, v249, v167, v168
    v_max3_f32 v249, v249, v169, v170
    v_max3_f32 v249, v249, v171, v172
    v_max3_f32 v249, v249, v173, v174
    v_max_f32 v249, v249, v175
    v_max3_f32 v250, v224, v225, v226
    v_max3_f32 v250, v250, v227, v228
    v_max3_f32 v250, v250, v229, v230
    v_max3_f32 v250, v250, v231, v232
    v_max3_f32 v250, v250, v233, v234
    v_max3_f32 v250, v250, v235, v236
    v_max3_f32 v250, v250, v237, v238
    v_max_f32 v250, v250, v239
    v_max3_f32 v251, v64, v65, v66
    v_max3_f32 v251, v251, v67, v68
    v_max3_f32 v251, v251, v69, v70
    v_max3_f32 v251, v251, v71, v72
    v_max3_f32 v251, v251, v73, v74
    v_max3_f32 v251, v251, v75, v76
    v_max3_f32 v251, v251, v77, v78
    v_max_f32 v251, v251, v79
    v_mov_b32 v252, v248
    v_mov_b32 v253, v249
    v_mov_b32 v254, v250
    v_mov_b32 v255, v251
    v_mov_b32 v64, 0
    v_mov_b32 v65, 0
    v_mov_b32 v66, 0
    v_mov_b32 v67, 0
    v_mov_b32 v68, 0
    v_mov_b32 v69, 0
    v_mov_b32 v70, 0
    v_mov_b32 v71, 0
    v_mov_b32 v72, 0
    v_mov_b32 v73, 0
    v_mov_b32 v74, 0
    v_mov_b32 v75, 0
    v_mov_b32 v76, 0
    v_mov_b32 v77, 0
    v_mov_b32 v78, 0
    v_mov_b32 v79, 0
    v_permlane32_swap_b32 v248, v252
    v_permlane32_swap_b32 v249, v253
    v_permlane32_swap_b32 v250, v254
    v_permlane32_swap_b32 v251, v255
    s_nop 1
    v_max_f32 v248, v248, v252
    v_max_f32 v249, v249, v253
    v_max_f32 v250, v250, v254
    v_max_f32 v251, v251, v255
    v_sub_f32 v248, 0xc2c00000, v248
    v_sub_f32 v249, 0xc2c00000, v249
    v_sub_f32 v250, 0xc2c00000, v250
    v_sub_f32 v251, 0xc2c00000, v251
    v_cvt_pk_bf16_f32 v248, v248, 0
    v_cvt_pk_bf16_f32 v249, v249, 0
    v_cvt_pk_bf16_f32 v250, v250, 0
    v_cvt_pk_bf16_f32 v251, v251, 0
    v_cndmask_b32 v86, v86, v248, s[64:65]
    v_cndmask_b32 v94, v94, v249, s[64:65]
    v_cndmask_b32 v102, v102, v250, s[64:65]
    v_cndmask_b32 v110, v110, v251, s[64:65]
    s_waitcnt vmcnt(12)
    v_mfma_f32_32x32x16_bf16 v[144:159], v[112:115], v[80:83], 0
    v_mfma_f32_32x32x16_bf16 v[144:159], v[116:119], v[84:87], v[144:159]
    s_nop 7
    s_nop 3
L2_loop:
    v_mfma_f32_32x32x16_bf16 v[160:175], v[112:115], v[88:91], 0
    v_exp_f32 v144, v144
    v_exp_f32 v145, v145
    v_exp_f32 v146, v146
    v_mfma_f32_32x32x16_bf16 v[160:175], v[116:119], v[92:95], v[160:175]
    v_exp_f32 v147, v147
    v_exp_f32 v148, v148
    v_exp_f32 v149, v149
    v_exp_f32 v150, v150
    v_exp_f32 v151, v151
    v_cvt_pk_bf16_f32 v176, v144, v145
    v_cvt_pk_bf16_f32 v177, v146, v147
    v_cvt_pk_bf16_f32 v178, v148, v149
    v_cvt_pk_bf16_f32 v179, v150, v151
    s_cmp_eq_u32 s62, 0
    s_cbranch_scc1 L2_skip_first
    v_mfma_f32_32x32x16_bf16 v[64:79], v[212:215], v[180:183], v[64:79]
L2_skip_first:
    v_exp_f32 v152, v152
    v_exp_f32 v153, v153
    v_exp_f32 v154, v154
    s_waitcnt vmcnt(10)
    v_mfma_f32_32x32x16_bf16 v[16:31], v[184:187], v[176:179], v[16:31]
    v_exp_f32 v155, v155
    v_exp_f32 v156, v156
    v_exp_f32 v157, v157
    v_exp_f32 v158, v158
    v_exp_f32 v159, v159
    v_cvt_pk_bf16_f32 v180, v152, v153
    v_cvt_pk_bf16_f32 v181, v154, v155
    v_cvt_pk_bf16_f32 v182, v156, v157
    v_cvt_pk_bf16_f32 v183, v158, v159
    v_mfma_f32_32x32x16_bf16 v[144:159], v[112:115], v[96:99], 0
    v_exp_f32 v160, v160
    v_exp_f32 v161, v161
    v_exp_f32 v162, v162
    v_mfma_f32_32x32x16_bf16 v[144:159], v[116:119], v[100:103], v[144:159]
    v_exp_f32 v163, v163
    v_exp_f32 v164, v164
    v_exp_f32 v165, v165
    v_exp_f32 v166, v166
    v_exp_f32 v167, v167
    v_cvt_pk_bf16_f32 v176, v160, v161
    v_cvt_pk_bf16_f32 v177, v162, v163
    v_cvt_pk_bf16_f32 v178, v164, v165
    v_cvt_pk_bf16_f32 v179, v166, v167
    buffer_load_dwordx4 v[208:211], v1, s[44:47], s61 offen sc1
    buffer_load_dwordx4 v[212:215], v1, s[44:47], s61 offen offset:1024 sc1
    s_add_u32 s61, s61, 2048
    v_mfma_f32_32x32x16_bf16 v[16:31], v[188:191], v[180:183], v[16:31]
    v_exp_f32 v168, v168
    v_exp_f32 v169, v169
    v_exp_f32 v170, v170
    v_mfma_f32_32x32x16_bf16 v[32:47], v[184:187], v[176:179], v[32:47]
    v_exp_f32 v171, v171
    v_exp_f32 v172, v172
    v_exp_f32 v173, v173
    v_exp_f32 v174, v174
    v_exp_f32 v175, v175
    v_cvt_pk_bf16_f32 v180, v168, v169
    v_cvt_pk_bf16_f32 v181, v170, v171
    v_cvt_pk_bf16_f32 v182, v172, v173
    v_cvt_pk_bf16_f32 v183, v174, v175
    v_mfma_f32_32x32x16_bf16 v[160:175], v[112:115], v[104:107], 0
    v_exp_f32 v144, v144
    v_exp_f32 v145, v145
    v_exp_f32 v146, v146
    v_mfma_f32_32x32x16_bf16 v[160:175], v[116:119], v[108:111], v[160:175]
    v_exp_f32 v147, v147
    v_exp_f32 v148, v148
    v_exp_f32 v149, v149
    v_exp_f32 v150, v150
    v_exp_f32 v151, v151
    v_cvt_pk_bf16_f32 v176, v144, v145
    v_cvt_pk_bf16_f32 v177, v146, v147
    v_cvt_pk_bf16_f32 v178, v148, v149
    v_cvt_pk_bf16_f32 v179, v150, v151
    v_mfma_f32_32x32x16_bf16 v[32:47], v[188:191], v[180:183], v[32:47]
    v_exp_f32 v152, v152
    v_exp_f32 v153, v153
    v_exp_f32 v154, v154
    v_mfma_f32_32x32x16_bf16 v[48:63], v[184:187], v[176:179], v[48:63]
    v_exp_f32 v155, v155
    v_exp_f32 v156, v156
    v_exp_f32 v157, v157
    v_exp_f32 v158, v158
    v_exp_f32 v159, v159
    v_cvt_pk_bf16_f32 v180, v152, v153
    v_cvt_pk_bf16_f32 v181, v154, v155
    v_cvt_pk_bf16_f32 v182, v156, v157
    v_cvt_pk_bf16_f32 v183, v158, v159
    s_waitcnt vmcnt(10)
    v_mfma_f32_32x32x16_bf16 v[144:159], v[120:123], v[80:83], 0
    v_exp_f32 v160, v160
    v_exp_f32 v161, v161
    v_exp_f32 v162, v162
    v_mfma_f32_32x32x16_bf16 v[144:159], v[124:127], v[84:87], v[144:159]
    v_exp_f32 v163, v163
    v_exp_f32 v164, v164
    v_exp_f32 v165, v165
    v_exp_f32 v166, v166
    v_exp_f32 v167, v167
    v_cvt_pk_bf16_f32 v176, v160, v161
    v_cvt_pk_bf16_f32 v177, v162, v163
    v_cvt_pk_bf16_f32 v178, v164, v165
    v_cvt_pk_bf16_f32 v179, v166, v167
    buffer_load_dwordx4 v[112:115], v1, s[40:43], s60 offen sc1
    buffer_load_dwordx4 v[116:119], v1, s[40:43], s60 offen offset:1024 sc1
    s_add_u32 s60, s60, 2048
    v_mfma_f32_32x32x16_bf16 v[48:63], v[188:191], v[180:183], v[48:63]
    v_exp_f32 v168, v168
    v_exp_f32 v169, v169
    v_exp_f32 v170, v170
    v_mfma_f32_32x32x16_bf16 v[64:79], v[184:187], v[176:179], v[64:79]
    v_exp_f32 v171, v171
    v_exp_f32 v172, v172
    v_exp_f32 v173, v173
    v_exp_f32 v174, v174
    v_exp_f32 v175, v175
    v_cvt_pk_bf16_f32 v180, v168, v169
    v_cvt_pk_bf16_f32 v181, v170, v171
    v_cvt_pk_bf16_f32 v182, v172, v173
    v_cvt_pk_bf16_f32 v183, v174, v175
    v_mfma_f32_32x32x16_bf16 v[160:175], v[120:123], v[88:91], 0
    v_exp_f32 v144, v144
    v_exp_f32 v145, v145
    v_exp_f32 v146, v146
    v_mfma_f32_32x32x16_bf16 v[160:175], v[124:127], v[92:95], v[160:175]
    v_exp_f32 v147, v147
    v_exp_f32 v148, v148
    v_exp_f32 v149, v149
    v_exp_f32 v150, v150
    v_exp_f32 v151, v151
    v_cvt_pk_bf16_f32 v176, v144, v145
    v_cvt_pk_bf16_f32 v177, v146, v147
    v_cvt_pk_bf16_f32 v178, v148, v149
    v_cvt_pk_bf16_f32 v179, v150, v151
    v_mfma_f32_32x32x16_bf16 v[64:79], v[188:191], v[180:183], v[64:79]
    v_exp_f32 v152, v152
    v_exp_f32 v153, v153
    v_exp_f32 v154, v154
    s_waitcnt vmcnt(10)
    v_mfma_f32_32x32x16_bf16 v[16:31], v[192:195], v[176:179], v[16:31]
    v_exp_f32 v155, v155
    v_exp_f32 v156, v156
    v_exp_f32 v157, v157
    v_exp_f32 v158, v158
    v_exp_f32 v159, v159
    v_cvt_pk_bf16_f32 v180, v152, v153
    v_cvt_pk_bf16_f32 v181, v154, v155
    v_cvt_pk_bf16_f32 v182, v156, v157
    v_cvt_pk_bf16_f32 v183, v158, v159
    v_mfma_f32_32x32x16_bf16 v[144:159], v[120:123], v[96:99], 0
    v_exp_f32 v160, v160
    v_exp_f32 v161, v161
    v_exp_f32 v162, v162
    v_mfma_f32_32x32x16_bf16 v[144:159], v[124:127], v[100:103], v[144:159]
    v_exp_f32 v163, v163
    v_exp_f32 v164, v164
    v_exp_f32 v165, v165
    v_exp_f32 v166, v166
    v_exp_f32 v167, v167
    v_cvt_pk_bf16_f32 v176, v160, v161
    v_cvt_pk_bf16_f32 v177, v162, v163
    v_cvt_pk_bf16_f32 v178, v164, v165
    v_cvt_pk_bf16_f32 v179, v166, v167
    buffer_load_dwordx4 v[184:187], v1, s[44:47], s61 offen sc1
    buffer_load_dwordx4 v[188:191], v1, s[44:47], s61 offen offset:1024 sc1
    s_add_u32 s61, s61, 2048
    v_mfma_f32_32x32x16_bf16 v[16:31], v[196:199], v[180:183], v[16:31]
    v_exp_f32 v168, v168
    v_exp_f32 v169, v169
    v_exp_f32 v170, v170
    v_mfma_f32_32x32x16_bf16 v[32:47], v[192:195], v[176:179], v[32:47]
    v_exp_f32 v171, v171
    v_exp_f32 v172, v172
    v_exp_f32 v173, v173
    v_exp_f32 v174, v174
    v_exp_f32 v175, v175
    v_cvt_pk_bf16_f32 v180, v168, v169
    v_cvt_pk_bf16_f32 v181, v170, v171
    v_cvt_pk_bf16_f32 v182, v172, v173
    v_cvt_pk_bf16_f32 v183, v174, v175
    v_mfma_f32_32x32x16_bf16 v[160:175], v[120:123], v[104:107], 0
    v_exp_f32 v144, v144
    v_exp_f32 v145, v145
    v_exp_f32 v146, v146
    v_mfma_f32_32x32x16_bf16 v[160:175], v[124:127], v[108:111], v[160:175]
    v_exp_f32 v147, v147
    v_exp_f32 v148, v148
    v_exp_f32 v149, v149
    v_exp_f32 v150, v150
    v_exp_f32 v151, v151
    v_cvt_pk_bf16_f32 v176, v144, v145
    v_cvt_pk_bf16_f32 v177, v146, v147
    v_cvt_pk_bf16_f32 v178, v148, v149
    v_cvt_pk_bf16_f32 v179, v150, v151
    v_mfma_f32_32x32x16_bf16 v[32:47], v[196:199], v[180:183], v[32:47]
    v_exp_f32 v152, v152
    v_exp_f32 v153, v153
    v_exp_f32 v154, v154
    v_mfma_f32_32x32x16_bf16 v[48:63], v[192:195], v[176:179], v[48:63]
    v_exp_f32 v155, v155
    v_exp_f32 v156, v156
    v_exp_f32 v157, v157
    v_exp_f32 v158, v158
    v_exp_f32 v159, v159
    v_cvt_pk_bf16_f32 v180, v152, v153
    v_cvt_pk_bf16_f32 v181, v154, v155
    v_cvt_pk_bf16_f32 v182, v156, v157
    v_cvt_pk_bf16_f32 v183, v158, v159
    s_waitcnt vmcnt(10)
    v_mfma_f32_32x32x16_bf16 v[144:159], v[128:131], v[80:83], 0
    v_exp_f32 v160, v160
    v_exp_f32 v161, v161
    v_exp_f32 v162, v162
    v_mfma_f32_32x32x16_bf16 v[144:159], v[132:135], v[84:87], v[144:159]
    v_exp_f32 v163, v163
    v_exp_f32 v164, v164
    v_exp_f32 v165, v165
    v_exp_f32 v166, v166
    v_exp_f32 v167, v167
    v_cvt_pk_bf16_f32 v176, v160, v161
    v_cvt_pk_bf16_f32 v177, v162, v163
    v_cvt_pk_bf16_f32 v178, v164, v165
    v_cvt_pk_bf16_f32 v179, v166, v167
    buffer_load_dwordx4 v[120:123], v1, s[40:43], s60 offen sc1
    buffer_load_dwordx4 v[124:127], v1, s[40:43], s60 offen offset:1024 sc1
    s_add_u32 s60, s60, 2048
    v_mfma_f32_32x32x16_bf16 v[48:63], v[196:199], v[180:183], v[48:63]
    v_exp_f32 v168, v168
    v_exp_f32 v169, v169
    v_exp_f32 v170, v170
    v_mfma_f32_32x32x16_bf16 v[64:79], v[192:195], v[176:179], v[64:79]
    v_exp_f32 v171, v171
    v_exp_f32 v172, v172
    v_exp_f32 v173, v173
    v_exp_f32 v174, v174
    v_exp_f32 v175, v175
    v_cvt_pk_bf16_f32 v180, v168, v169
    v_cvt_pk_bf16_f32 v181, v170, v171
    v_cvt_pk_bf16_f32 v182, v172, v173
    v_cvt_pk_bf16_f32 v183, v174, v175
    v_mfma_f32_32x32x16_bf16 v[160:175], v[128:131], v[88:91], 0
    v_exp_f32 v144, v144
    v_exp_f32 v145, v145
    v_exp_f32 v146, v146
    v_mfma_f32_32x32x16_bf16 v[160:175], v[132:135], v[92:95], v[160:175]
    v_exp_f32 v147, v147
    v_exp_f32 v148, v148
    v_exp_f32 v149, v149
    v_exp_f32 v150, v150
    v_exp_f32 v151, v151
    v_cvt_pk_bf16_f32 v176, v144, v145
    v_cvt_pk_bf16_f32 v177, v146, v147
    v_cvt_pk_bf16_f32 v178, v148, v149
    v_cvt_pk_bf16_f32 v179, v150, v151
    v_mfma_f32_32x32x16_bf16 v[64:79], v[196:199], v[180:183], v[64:79]
    v_exp_f32 v152, v152
    v_exp_f32 v153, v153
    v_exp_f32 v154, v154
    s_waitcnt vmcnt(10)
    v_mfma_f32_32x32x16_bf16 v[16:31], v[200:203], v[176:179], v[16:31]
    v_exp_f32 v155, v155
    v_exp_f32 v156, v156
    v_exp_f32 v157, v157
    v_exp_f32 v158, v158
    v_exp_f32 v159, v159
    v_cvt_pk_bf16_f32 v180, v152, v153
    v_cvt_pk_bf16_f32 v181, v154, v155
    v_cvt_pk_bf16_f32 v182, v156, v157
    v_cvt_pk_bf16_f32 v183, v158, v159
    v_mfma_f32_32x32x16_bf16 v[144:159], v[128:131], v[96:99], 0
    v_exp_f32 v160, v160
    v_exp_f32 v161, v161
    v_exp_f32 v162, v162
    v_mfma_f32_32x32x16_bf16 v[144:159], v[132:135], v[100:103], v[144:159]
    v_exp_f32 v163, v163
    v_exp_f32 v164, v164
    v_exp_f32 v165, v165
    v_exp_f32 v166, v166
    v_exp_f32 v167, v167
    v_cvt_pk_bf16_f32 v176, v160, v161
    v_cvt_pk_bf16_f32 v177, v162, v163
    v_cvt_pk_bf16_f32 v178, v164, v165
    v_cvt_pk_bf16_f32 v179, v166, v167
    buffer_load_dwordx4 v[192:195], v1, s[44:47], s61 offen sc1
    buffer_load_dwordx4 v[196:199], v1, s[44:47], s61 offen offset:1024 sc1
    s_add_u32 s61, s61, 2048
    v_mfma_f32_32x32x16_bf16 v[16:31], v[204:207], v[180:183], v[16:31]
    v_exp_f32 v168, v168
    v_exp_f32 v169, v169
    v_exp_f32 v170, v170
    v_mfma_f32_32x32x16_bf16 v[32:47], v[200:203], v[176:179], v[32:47]
    v_exp_f32 v171, v171
    v_exp_f32 v172, v172
    v_exp_f32 v173, v173
    v_exp_f32 v174, v174
    v_exp_f32 v175, v175
    v_cvt_pk_bf16_f32 v180, v168, v169
    v_cvt_pk_bf16_f32 v181, v170, v171
    v_cvt_pk_bf16_f32 v182, v172, v173
    v_cvt_pk_bf16_f32 v183, v174, v175
    v_mfma_f32_32x32x16_bf16 v[160:175], v[128:131], v[104:107], 0
    v_exp_f32 v144, v144
    v_exp_f32 v145, v145
    v_exp_f32 v146, v146
    v_mfma_f32_32x32x16_bf16 v[160:175], v[132:135], v[108:111], v[160:175]
    v_exp_f32 v147, v147
    v_exp_f32 v148, v148
    v_exp_f32 v149, v149
    v_exp_f32 v150, v150
    v_exp_f32 v151, v151
    v_cvt_pk_bf16_f32 v176, v144, v145
    v_cvt_pk_bf16_f32 v177, v146, v147
    v_cvt_pk_bf16_f32 v178, v148, v149
    v_cvt_pk_bf16_f32 v179, v150, v151
    v_mfma_f32_32x32x16_bf16 v[32:47], v[204:207], v[180:183], v[32:47]
    v_exp_f32 v152, v152
    v_exp_f32 v153, v153
    v_exp_f32 v154, v154
    v_mfma_f32_32x32x16_bf16 v[48:63], v[200:203], v[176:179], v[48:63]
    v_exp_f32 v155, v155
    v_exp_f32 v156, v156
    v_exp_f32 v157, v157
    v_exp_f32 v158, v158
    v_exp_f32 v159, v159
    v_cvt_pk_bf16_f32 v180, v152, v153
    v_cvt_pk_bf16_f32 v181, v154, v155
    v_cvt_pk_bf16_f32 v182, v156, v157
    v_cvt_pk_bf16_f32 v183, v158, v159
    s_waitcnt vmcnt(10)
    v_mfma_f32_32x32x16_bf16 v[144:159], v[136:139], v[80:83], 0
    v_exp_f32 v160, v160
    v_exp_f32 v161, v161
    v_exp_f32 v162, v162
    v_mfma_f32_32x32x16_bf16 v[144:159], v[140:143], v[84:87], v[144:159]
    v_exp_f32 v163, v163
    v_exp_f32 v164, v164
    v_exp_f32 v165, v165
    v_exp_f32 v166, v166
    v_exp_f32 v167, v167
    v_cvt_pk_bf16_f32 v176, v160, v161
    v_cvt_pk_bf16_f32 v177, v162, v163
    v_cvt_pk_bf16_f32 v178, v164, v165
    v_cvt_pk_bf16_f32 v179, v166, v167
    buffer_load_dwordx4 v[128:131], v1, s[40:43], s60 offen sc1
    buffer_load_dwordx4 v[132:135], v1, s[40:43], s60 offen offset:1024 sc1
    s_add_u32 s60, s60, 2048
    v_mfma_f32_32x32x16_bf16 v[48:63], v[204:207], v[180:183], v[48:63]
    v_exp_f32 v168, v168
    v_exp_f32 v169, v169
    v_exp_f32 v170, v170
    v_mfma_f32_32x32x16_bf16 v[64:79], v[200:203], v[176:179], v[64:79]
    v_exp_f32 v171, v171
    v_exp_f32 v172, v172
    v_exp_f32 v173, v173
    v_exp_f32 v174, v174
    v_exp_f32 v175, v175
    v_cvt_pk_bf16_f32 v180, v168, v169
    v_cvt_pk_bf16_f32 v181, v170, v171
    v_cvt_pk_bf16_f32 v182, v172, v173
    v_cvt_pk_bf16_f32 v183, v174, v175
    v_mfma_f32_32x32x16_bf16 v[160:175], v[136:139], v[88:91], 0
    v_exp_f32 v144, v144
    v_exp_f32 v145, v145
    v_exp_f32 v146, v146
    v_mfma_f32_32x32x16_bf16 v[160:175], v[140:143], v[92:95], v[160:175]
    v_exp_f32 v147, v147
    v_exp_f32 v148, v148
    v_exp_f32 v149, v149
    v_exp_f32 v150, v150
    v_exp_f32 v151, v151
    v_cvt_pk_bf16_f32 v176, v144, v145
    v_cvt_pk_bf16_f32 v177, v146, v147
    v_cvt_pk_bf16_f32 v178, v148, v149
    v_cvt_pk_bf16_f32 v179, v150, v151
    v_mfma_f32_32x32x16_bf16 v[64:79], v[204:207], v[180:183], v[64:79]
    v_exp_f32 v152, v152
    v_exp_f32 v153, v153
    v_exp_f32 v154, v154
    s_waitcnt vmcnt(10)
    v_mfma_f32_32x32x16_bf16 v[16:31], v[208:211], v[176:179], v[16:31]
    v_exp_f32 v155, v155
    v_exp_f32 v156, v156
    v_exp_f32 v157, v157
    v_exp_f32 v158, v158
    v_exp_f32 v159, v159
    v_cvt_pk_bf16_f32 v180, v152, v153
    v_cvt_pk_bf16_f32 v181, v154, v155
    v_cvt_pk_bf16_f32 v182, v156, v157
    v_cvt_pk_bf16_f32 v183, v158, v159
    v_mfma_f32_32x32x16_bf16 v[144:159], v[136:139], v[96:99], 0
    v_exp_f32 v160, v160
    v_exp_f32 v161, v161
    v_exp_f32 v162, v162
    v_mfma_f32_32x32x16_bf16 v[144:159], v[140:143], v[100:103], v[144:159]
    v_exp_f32 v163, v163
    v_exp_f32 v164, v164
    v_exp_f32 v165, v165
    v_exp_f32 v166, v166
    v_exp_f32 v167, v167
    v_cvt_pk_bf16_f32 v176, v160, v161
    v_cvt_pk_bf16_f32 v177, v162, v163
    v_cvt_pk_bf16_f32 v178, v164, v165
    v_cvt_pk_bf16_f32 v179, v166, v167
    buffer_load_dwordx4 v[200:203], v1, s[44:47], s61 offen sc1
    buffer_load_dwordx4 v[204:207], v1, s[44:47], s61 offen offset:1024 sc1
    s_add_u32 s61, s61, 2048
    v_mfma_f32_32x32x16_bf16 v[16:31], v[212:215], v[180:183], v[16:31]
    v_exp_f32 v168, v168
    v_exp_f32 v169, v169
    v_exp_f32 v170, v170
    v_mfma_f32_32x32x16_bf16 v[32:47], v[208:211], v[176:179], v[32:47]
    v_exp_f32 v171, v171
    v_exp_f32 v172, v172
    v_exp_f32 v173, v173
    v_exp_f32 v174, v174
    v_exp_f32 v175, v175
    v_cvt_pk_bf16_f32 v180, v168, v169
    v_cvt_pk_bf16_f32 v181, v170, v171
    v_cvt_pk_bf16_f32 v182, v172, v173
    v_cvt_pk_bf16_f32 v183, v174, v175
    v_mfma_f32_32x32x16_bf16 v[160:175], v[136:139], v[104:107], 0
    v_exp_f32 v144, v144
    v_exp_f32 v145, v145
    v_exp_f32 v146, v146
    v_mfma_f32_32x32x16_bf16 v[160:175], v[140:143], v[108:111], v[160:175]
    v_exp_f32 v147, v147
    v_exp_f32 v148, v148
    v_exp_f32 v149, v149
    v_exp_f32 v150, v150
    v_exp_f32 v151, v151
    v_cvt_pk_bf16_f32 v176, v144, v145
    v_cvt_pk_bf16_f32 v177, v146, v147
    v_cvt_pk_bf16_f32 v178, v148, v149
    v_cvt_pk_bf16_f32 v179, v150, v151
    v_mfma_f32_32x32x16_bf16 v[32:47], v[212:215], v[180:183], v[32:47]
    v_exp_f32 v152, v152
    v_exp_f32 v153, v153
    v_exp_f32 v154, v154
    v_mfma_f32_32x32x16_bf16 v[48:63], v[208:211], v[176:179], v[48:63]
    v_exp_f32 v155, v155
    v_exp_f32 v156, v156
    v_exp_f32 v157, v157
    v_exp_f32 v158, v158
    v_exp_f32 v159, v159
    v_cvt_pk_bf16_f32 v180, v152, v153
    v_cvt_pk_bf16_f32 v181, v154, v155
    v_cvt_pk_bf16_f32 v182, v156, v157
    v_cvt_pk_bf16_f32 v183, v158, v159
    s_waitcnt vmcnt(10)
    v_mfma_f32_32x32x16_bf16 v[144:159], v[112:115], v[80:83], 0
    v_exp_f32 v160, v160
    v_exp_f32 v161, v161
    v_exp_f32 v162, v162
    v_mfma_f32_32x32x16_bf16 v[144:159], v[116:119], v[84:87], v[144:159]
    v_exp_f32 v163, v163
    v_exp_f32 v164, v164
    v_exp_f32 v165, v165
    v_exp_f32 v166, v166
    v_exp_f32 v167, v167
    v_cvt_pk_bf16_f32 v176, v160, v161
    v_cvt_pk_bf16_f32 v177, v162, v163
    v_cvt_pk_bf16_f32 v178, v164, v165
    v_cvt_pk_bf16_f32 v179, v166, v167
    buffer_load_dwordx4 v[136:139], v1, s[40:43], s60 offen sc1
    buffer_load_dwordx4 v[140:143], v1, s[40:43], s60 offen offset:1024 sc1
    s_add_u32 s60, s60, 2048
    v_mfma_f32_32x32x16_bf16 v[48:63], v[212:215], v[180:183], v[48:63]
    v_exp_f32 v168, v168
    v_exp_f32 v169, v169
    v_exp_f32 v170, v170
    v_mfma_f32_32x32x16_bf16 v[64:79], v[208:211], v[176:179], v[64:79]
    v_exp_f32 v171, v171
    v_exp_f32 v172, v172
    v_exp_f32 v173, v173
    v_exp_f32 v174, v174
    v_exp_f32 v175, v175
    v_cvt_pk_bf16_f32 v180, v168, v169
    v_cvt_pk_bf16_f32 v181, v170, v171
    v_cvt_pk_bf16_f32 v182, v172, v173
    v_cvt_pk_bf16_f32 v183, v174, v175
    s_add_u32 s62, s62, 1
    s_cmp_eq_u32 s62, 3
    s_cbranch_scc1 L2_lcchk
L2_lcback:
    s_cmp_lt_u32 s62, 4
    s_cbranch_scc1 L2_loop
    s_nop 1
    v_mfma_f32_32x32x16_bf16 v[64:79], v[212:215], v[180:183], v[64:79]
    s_lshl_b32 s70, s37, 12
    v_add_u32 v248, s70, v1
    s_cmp_eq_u32 s37, 0
    s_cbranch_scc1 L2_wskip0
    ds_write_b128 v248, v[16:19] offset:0
    ds_write_b128 v248, v[20:23] offset:1024
    ds_write_b128 v248, v[24:27] offset:2048
    ds_write_b128 v248, v[28:31] offset:3072
L2_wskip0:
    s_cmp_eq_u32 s37, 1
    s_cbranch_scc1 L2_wskip1
    ds_write_b128 v248, v[32:35] offset:16384
    ds_write_b128 v248, v[36:39] offset:17408
    ds_write_b128 v248, v[40:43] offset:18432
    ds_write_b128 v248, v[44:47] offset:19456
L2_wskip1:
    s_cmp_eq_u32 s37, 2
    s_cbranch_scc1 L2_wskip2
    ds_write_b128 v248, v[48:51] offset:32768
    ds_write_b128 v248, v[52:55] offset:33792
    ds_write_b128 v248, v[56:59] offset:34816
    ds_write_b128 v248, v[60:63] offset:35840
L2_wskip2:
    s_nop 7
    s_cmp_eq_u32 s37, 3
    s_cbranch_scc1 L2_wskip3
    ds_write_b128 v248, v[64:67] offset:49152
    ds_write_b128 v248, v[68:71] offset:50176
    ds_write_b128 v248, v[72:75] offset:51200
    ds_write_b128 v248, v[76:79] offset:52224
L2_wskip3:
    s_waitcnt vmcnt(0) lgkmcnt(0)
    v_mov_b32 v249, 163352
    v_mov_b32 v250, 1
    s_mov_b64 exec, 1
    ds_add_u32 v249, v250
    s_mov_b64 exec, -1
    s_mov_b32 s78, 1048576
L2_redw:
    ds_read_b32 v250, v249
    s_waitcnt lgkmcnt(0)
    v_readfirstlane_b32 s79, v250
    s_nop 3
    s_cmp_ge_u32 s79, 4
    s_cbranch_scc1 L2_redx
    s_sub_u32 s78, s78, 1
    s_cmp_lg_u32 s78, 0
    s_cbranch_scc1 L2_redw
L2_redx:
    s_lshl_b32 s70, s37, 14
    v_add_u32 v248, s70, v1
    s_cmp_eq_u32 s37, 0
    s_cbranch_scc1 L2_rskip0
    ds_read_b128 v[16:19], v248 offset:0
    ds_read_b128 v[20:23], v248 offset:1024
    ds_read_b128 v[24:27], v248 offset:2048
    ds_read_b128 v[28:31], v248 offset:3072
L2_rskip0:
    s_cmp_eq_u32 s37, 1
    s_cbranch_scc1 L2_rskip1
    ds_read_b128 v[32:35], v248 offset:4096
    ds_read_b128 v[36:39], v248 offset:5120
    ds_read_b128 v[40:43], v248 offset:6144
    ds_read_b128 v[44:47], v248 offset:7168
L2_rskip1:
    s_cmp_eq_u32 s37, 2
    s_cbranch_scc1 L2_rskip2
    ds_read_b128 v[48:51], v248 offset:8192
    ds_read_b128 v[52:55], v248 offset:9216
    ds_read_b128 v[56:59], v248 offset:10240
    ds_read_b128 v[60:63], v248 offset:11264
L2_rskip2:
    s_cmp_eq_u32 s37, 3
    s_cbranch_scc1 L2_rskip3
    ds_read_b128 v[64:67], v248 offset:12288
    ds_read_b128 v[68:71], v248 offset:13312
    ds_read_b128 v[72:75], v248 offset:14336
    ds_read_b128 v[76:79], v248 offset:15360
L2_rskip3:
    s_waitcnt lgkmcnt(0)
    v_add_f32 v16, v16, v32
    v_add_f32 v48, v48, v64
    v_add_f32 v17, v17, v33
    v_add_f32 v49, v49, v65
    v_add_f32 v18, v18, v34
    v_add_f32 v50, v50, v66
    v_add_f32 v19, v19, v35
    v_add_f32 v51, v51, v67
    v_add_f32 v20, v20, v36
    v_add_f32 v52, v52, v68
    v_add_f32 v21, v21, v37
    v_add_f32 v53, v53, v69
    v_add_f32 v22, v22, v38
    v_add_f32 v54, v54, v70
    v_add_f32 v23, v23, v39
    v_add_f32 v55, v55, v71
    v_add_f32 v24, v24, v40
    v_add_f32 v56, v56, v72
    v_add_f32 v25, v25, v41
    v_add_f32 v57, v57, v73
    v_add_f32 v26, v26, v42
    v_add_f32 v58, v58, v74
    v_add_f32 v27, v27, v43
    v_add_f32 v59, v59, v75
    v_add_f32 v28, v28, v44
    v_add_f32 v60, v60, v76
    v_add_f32 v29, v29, v45
    v_add_f32 v61, v61, v77
    v_add_f32 v30, v30, v46
    v_add_f32 v62, v62, v78
    v_add_f32 v31, v31, v47
    v_add_f32 v63, v63, v79
    v_add_f32 v16, v16, v48
    v_add_f32 v17, v17, v49
    v_add_f32 v18, v18, v50
    v_add_f32 v19, v19, v51
    v_add_f32 v20, v20, v52
    v_add_f32 v21, v21, v53
    v_add_f32 v22, v22, v54
    v_add_f32 v23, v23, v55
    v_add_f32 v24, v24, v56
    v_add_f32 v25, v25, v57
    v_add_f32 v26, v26, v58
    v_add_f32 v27, v27, v59
    v_add_f32 v28, v28, v60
    v_add_f32 v29, v29, v61
    v_add_f32 v30, v30, v62
    v_add_f32 v31, v31, v63
    s_mov_b32 s76, 0
L2_norm:
    v_mov_b32 v248, v28
    v_mov_b32 v249, v28
    s_nop 1
    v_permlane32_swap_b32 v248, v249
    s_nop 1
    v_rcp_f32 v250, v249
    s_nop 0
    v_mul_f32 v16, v16, v250
    v_mul_f32 v17, v17, v250
    v_mul_f32 v18, v18, v250
    v_mul_f32 v19, v19, v250
    v_mul_f32 v20, v20, v250
    v_mul_f32 v21, v21, v250
    v_mul_f32 v22, v22, v250
    v_mul_f32 v23, v23, v250
    v_mul_f32 v24, v24, v250
    v_mul_f32 v25, v25, v250
    v_mul_f32 v26, v26, v250
    v_mul_f32 v27, v27, v250
    v_mul_f32 v28, v28, v250
    v_mul_f32 v29, v29, v250
    v_mul_f32 v30, v30, v250
    v_mul_f32 v31, v31, v250
    s_cmp_lg_u32 s76, 0
    s_cbranch_scc1 L2_store
    v_mov_b32 v251, 0xd800000
    v_mov_b32 v252, 0x7b800000
    v_cmp_nge_f32 vcc, v249, v251
    v_cmp_nle_f32 s[78:79], v249, v252
    s_or_b64 s[78:79], s[78:79], vcc
    v_mul_f32 v253, 0, v16
    v_fma_f32 v253, v17, 0, v253
    v_fma_f32 v253, v18, 0, v253
    v_fma_f32 v253, v19, 0, v253
    v_fma_f32 v253, v20, 0, v253
    v_fma_f32 v253, v21, 0, v253
    v_fma_f32 v253, v22, 0, v253
    v_fma_f32 v253, v23, 0, v253
    v_fma_f32 v253, v24, 0, v253
    v_fma_f32 v253, v25, 0, v253
    v_fma_f32 v253, v26, 0, v253
    v_fma_f32 v253, v27, 0, v253
    v_fma_f32 v253, v28, 0, v253
    v_fma_f32 v253, v29, 0, v253
    v_fma_f32 v253, v30, 0, v253
    v_fma_f32 v253, v31, 0, v253
    v_cmp_u_f32 vcc, v253, v253
    s_or_b64 s[78:79], s[78:79], vcc
    s_cmp_lg_u64 s[78:79], 0
    s_cbranch_scc1 L2_slow
L2_store:
    v_cvt_pk_bf16_f32 v176, v16, v17
    v_cvt_pk_bf16_f32 v177, v18, v19
    v_cvt_pk_bf16_f32 v178, v20, v21
    v_cvt_pk_bf16_f32 v179, v22, v23
    v_cvt_pk_bf16_f32 v180, v24, v25
    v_cvt_pk_bf16_f32 v181, v26, v27
    v_cvt_pk_bf16_f32 v182, v28, v29
    v_cvt_pk_bf16_f32 v183, v30, v31
    s_lshl_b32 s70, s35, 2
    s_add_u32 s70, s70, s37
    s_lshl_b32 s70, s70, 4
    s_add_u32 s70, s70, s34
    s_lshl_b32 s70, s70, 11
    s_add_u32 s70, s70, 16777216
    buffer_store_dwordx4 v[176:179], v1, s[48:51], s70 offen sc1
    buffer_store_dwordx4 v[180:183], v1, s[48:51], s70 offen offset:1024 sc1
    s_lshl_b32 s70, s35, 8
    s_lshl_b32 s71, s34, 2
    s_add_u32 s70, s70, s71
    s_add_u32 s70, s70, 27271168
    s_waitcnt vmcnt(0)
    v_mov_b32 v248, 163340
    v_mov_b32 v249, 1
    s_mov_b64 exec, 1
    ds_add_rtn_u32 v249, v248, v249
    s_waitcnt lgkmcnt(0)
    s_mov_b64 exec, -1
    v_readfirstlane_b32 s71, v249
    s_nop 3
    s_cmp_lg_u32 s71, 3
    s_cbranch_scc1 LA7x
    v_mov_b32 v248, s100
    v_mov_b32 v249, 0
    s_mov_b64 exec, 1
    buffer_store_dword v248, v249, s[48:51], s70 offen sc1
    s_mov_b64 exec, -1
LA7x:
    s_endpgm
L2_lcchk:
    v_mov_b32 v249, 163356
    s_mov_b32 s78, 1048576
LC8:
    ds_read_b32 v250, v249
    s_waitcnt lgkmcnt(0)
    v_readfirstlane_b32 s79, v250
    s_nop 3
    s_cmp_ge_u32 s79, 4
    s_cbranch_scc1 LC8x
    s_sleep 1
    s_sub_u32 s78, s78, 1
    s_cmp_lg_u32 s78, 0
    s_cbranch_scc1 LC8
LC8x:
    s_branch L2_lcback
L2_slow:
    s_lshl_b32 s70, s37, 11
    s_add_u32 s70, s70, s72
    buffer_load_dwordx4 v[80:83], v1, s[48:51], s70 offen sc1
    buffer_load_dwordx4 v[84:87], v1, s[48:51], s70 offen offset:1024 sc1
    v_mov_b32 v248, 0xff800000
    s_mov_b32 s71, s74
    s_mov_b32 s62, 0
L2_slow1:
    buffer_load_dwordx4 v[216:219], v1, s[48:51], s71 offen sc1
    buffer_load_dwordx4 v[220:223], v1, s[48:51], s71 offen offset:1024 sc1
    s_waitcnt vmcnt(0)
    v_mfma_f32_32x32x16_bf16 v[144:159], v[216:219], v[80:83], 0
    v_mfma_f32_32x32x16_bf16 v[144:159], v[220:223], v[84:87], v[144:159]
    s_nop 7
    s_nop 3
    v_max3_f32 v249, v144, v145, v146
    v_max3_f32 v249, v249, v147, v148
    v_max3_f32 v249, v249, v149, v150
    v_max3_f32 v249, v249, v151, v152
    v_max3_f32 v249, v249, v153, v154
    v_max3_f32 v249, v249, v155, v156
    v_max3_f32 v249, v249, v157, v158
    v_max_f32 v249, v249, v159
    v_max_f32 v248, v248, v249
    s_add_u32 s71, s71, 2048
    s_add_u32 s62, s62, 1
    s_cmp_lt_u32 s62, 64
    s_cbranch_scc1 L2_slow1
    v_mov_b32 v249, v248
    s_nop 1
    v_permlane32_swap_b32 v248, v249
    s_nop 1
    v_max_f32 v248, v248, v249
    v_sub_f32 v248, 0, v248
    v_cvt_pk_bf16_f32 v249, v248, 0
    v_lshlrev_b32 v250, 16, v249
    v_sub_f32 v251, v248, v250
    v_cvt_pk_bf16_f32 v252, v251, 0
    v_lshlrev_b32 v253, 16, v252
    v_sub_f32 v251, v251, v253
    v_cvt_pk_bf16_f32 v254, v251, 0
    v_or_b32 v249, v249, v253
    v_cndmask_b32 v86, v86, v249, s[64:65]
    v_cndmask_b32 v87, v87, v254, s[64:65]
    v_mov_b32 v16, 0
    v_mov_b32 v17, 0
    v_mov_b32 v18, 0
    v_mov_b32 v19, 0
    v_mov_b32 v20, 0
    v_mov_b32 v21, 0
    v_mov_b32 v22, 0
    v_mov_b32 v23, 0
    v_mov_b32 v24, 0
    v_mov_b32 v25, 0
    v_mov_b32 v26, 0
    v_mov_b32 v27, 0
    v_mov_b32 v28, 0
    v_mov_b32 v29, 0
    v_mov_b32 v30, 0
    v_mov_b32 v31, 0
    s_mov_b32 s71, s74
    s_mov_b32 s62, 0
L2_slow2:
    s_add_u32 s70, s71, 2097152
    buffer_load_dwordx4 v[216:219], v1, s[48:51], s71 offen sc1
    buffer_load_dwordx4 v[220:223], v1, s[48:51], s71 offen offset:1024 sc1
    buffer_load_dwordx4 v[224:227], v1, s[48:51], s70 offen sc1
    buffer_load_dwordx4 v[228:231], v1, s[48:51], s70 offen offset:1024 sc1
    s_waitcnt vmcnt(0)
    v_mfma_f32_32x32x16_bf16 v[144:159], v[216:219], v[80:83], 0
    v_mfma_f32_32x32x16_bf16 v[144:159], v[220:223], v[84:87], v[144:159]
    s_nop 7
    s_nop 3
    v_exp_f32 v144, v144
    v_exp_f32 v145, v145
    v_exp_f32 v146, v146
    v_exp_f32 v147, v147
    v_exp_f32 v148, v148
    v_exp_f32 v149, v149
    v_exp_f32 v150, v150
    v_exp_f32 v151, v151
    v_exp_f32 v152, v152
    v_exp_f32 v153, v153
    v_exp_f32 v154, v154
    v_exp_f32 v155, v155
    v_exp_f32 v156, v156
    v_exp_f32 v157, v157
    v_exp_f32 v158, v158
    v_exp_f32 v159, v159
    s_nop 0
    v_cvt_pk_bf16_f32 v176, v144, v145
    v_cvt_pk_bf16_f32 v177, v146, v147
    v_cvt_pk_bf16_f32 v178, v148, v149
    v_cvt_pk_bf16_f32 v179, v150, v151
    v_cvt_pk_bf16_f32 v180, v152, v153
    v_cvt_pk_bf16_f32 v181, v154, v155
    v_cvt_pk_bf16_f32 v182, v156, v157
    v_cvt_pk_bf16_f32 v183, v158, v159
    s_nop 1
    v_mfma_f32_32x32x16_bf16 v[16:31], v[224:227], v[176:179], v[16:31]
    v_mfma_f32_32x32x16_bf16 v[16:31], v[228:231], v[180:183], v[16:31]
    s_add_u32 s71, s71, 2048
    s_add_u32 s62, s62, 1
    s_cmp_lt_u32 s62, 64
    s_cbranch_scc1 L2_slow2
    s_nop 7
    s_nop 7
    s_mov_b32 s76, 1
    s_branch L2_norm
L2_ffn_entry:
    s_and_b32 s38, s2, 7
    s_lshr_b32 s39, s2, 3
    s_lshr_b32 s3, s39, 4
    s_lshl_b32 s34, s38, 1
    s_add_u32 s34, s34, s3
    s_and_b32 s35, s39, 15
    v_and_b32 v1, 63, v0
    v_lshlrev_b32 v1, 4, v1
    s_mov_b32 s64, 0
    s_mov_b32 s65, -1
    s_lshl_b32 s66, s37, 14
    s_add_u32 s66, s66, 65536
    v_and_b32 v248, 63, v0
    v_lshrrev_b32 v249, 3, v248
    v_bfe_u32 v250, v248, 4, 1
    v_lshlrev_b32 v250, 2, v250
    v_and_b32 v251, 7, v248
    v_xor_b32 v251, v251, v250
    v_lshlrev_b32 v251, 4, v251
    v_mul_u32_u24 v249, 896, v249
    v_add_u32 v161, v249, v251
    v_add_u32 v162, 6144, v161
    v_lshrrev_b32 v249, 5, v248
    v_lshlrev_b32 v249, 2, v249
    v_bfe_u32 v250, v248, 2, 2
    v_add_u32 v249, v249, v250
    v_lshlrev_b32 v249, 7, v249
    v_lshrrev_b32 v250, 1, v250
    v_lshlrev_b32 v250, 6, v250
    v_add_u32 v249, v249, v250
    v_bfe_u32 v250, v248, 4, 1
    v_lshlrev_b32 v250, 5, v250
    v_add_u32 v249, v249, v250
    v_and_b32 v250, 3, v248
    v_lshlrev_b32 v250, 3, v250
    v_add_u32 v249, v249, v250
    v_add_u32 v163, s66, v249
    v_xor_b32 v164, 64, v163
    s_cmp_ge_u32 s39, 28
    s_cbranch_scc1 L2_ffn_none
    s_mul_i32 s74, s39, 37
    s_lshr_b32 s74, s74, 8
    s_mul_i32 s75, s74, 7
    s_sub_u32 s75, s39, s75
    s_lshl_b32 s73, s75, 7
    s_lshl_b32 s76, s38, 2
    s_add_u32 s74, s74, s76
    s_lshl_b32 s74, s74, 1
    s_lshl_b32 s75, s75, 1
    s_lshr_b32 s76, s37, 1
    s_add_u32 s76, s76, s74
    s_and_b32 s77, s37, 1
    s_add_u32 s77, s77, s75
    s_mul_i32 s78, s37, 28672
    s_mul_i32 s68, s74, 114688
    s_add_u32 s68, s68, s78
    s_add_u32 s68, s68, 6291456
    s_add_u32 s69, s68, 114688
    s_mov_b32 s60, s28
    s_mov_b32 s61, s29
    s_mov_b32 s62, 1605632
    s_mov_b32 s63, 0x20000
    s_mul_i32 s67, s37, 401408
    s_add_u32 s67, s67, s73
    v_mov_b32 v160, v1
    v_mov_b32 v248, 163356
    s_mov_b32 s78, 1048576
LC9:
    ds_read_b32 v249, v248
    s_waitcnt lgkmcnt(0)
    v_readfirstlane_b32 s79, v249
    s_nop 3
    s_cmp_ge_u32 s79, 4
    s_cbranch_scc1 LC9x
    s_sleep 1
    s_sub_u32 s78, s78, 1
    s_cmp_lg_u32 s78, 0
    s_cbranch_scc1 LC9
LC9x:
    s_mov_b32 s60, s20
    s_mov_b32 s61, s21
    s_mov_b32 s62, 401408
    s_mov_b32 s63, 0x20000
    s_mul_i32 s67, s37, 100352
    s_add_u32 s67, s67, s73
    s_add_u32 m0, s66, 0
    s_nop 0
    buffer_load_dwordx4 v161, s[60:63], s67 offen lds
    buffer_load_dwordx4 v162, s[60:63], s67 offen offset:1024 lds
    s_add_u32 s67, s67, 14336
    s_add_u32 m0, s66, 2048
    s_nop 0
    buffer_load_dwordx4 v161, s[60:63], s67 offen lds
    buffer_load_dwordx4 v162, s[60:63], s67 offen offset:1024 lds
    s_add_u32 s67, s67, 10752
    s_add_u32 m0, s66, 4096
    s_nop 0
    buffer_load_dwordx4 v161, s[60:63], s67 offen lds
    buffer_load_dwordx4 v162, s[60:63], s67 offen offset:1024 lds
    s_add_u32 s67, s67, 14336
    s_add_u32 m0, s66, 6144
    s_nop 0
    buffer_load_dwordx4 v161, s[60:63], s67 offen lds
    buffer_load_dwordx4 v162, s[60:63], s67 offen offset:1024 lds
    s_add_u32 s67, s67, 10752
    s_add_u32 m0, s66, 8192
    s_nop 0
    buffer_load_dwordx4 v161, s[60:63], s67 offen lds
    buffer_load_dwordx4 v162, s[60:63], s67 offen offset:1024 lds
    s_add_u32 s67, s67, 14336
    s_add_u32 m0, s66, 10240
    s_nop 0
    buffer_load_dwordx4 v161, s[60:63], s67 offen lds
    buffer_load_dwordx4 v162, s[60:63], s67 offen offset:1024 lds
    s_add_u32 s67, s67, 10752
    s_add_u32 m0, s66, 12288
    s_nop 0
    buffer_load_dwordx4 v161, s[60:63], s67 offen lds
    buffer_load_dwordx4 v162, s[60:63], s67 offen offset:1024 lds
    s_add_u32 s67, s67, 14336
    s_add_u32 m0, s66, 14336
    s_nop 0
    buffer_load_dwordx4 v161, s[60:63], s67 offen lds
    buffer_load_dwordx4 v162, s[60:63], s67 offen offset:1024 lds
    s_add_u32 s67, s67, 10752
    s_waitcnt vmcnt(0)
    v_mov_b32 v252, 0
    ds_read_b64_tr_b16 v[168:169], v163 offset:0
    ds_read_b64_tr_b16 v[170:171], v163 offset:1024
    ds_read_b64_tr_b16 v[172:173], v164 offset:0
    ds_read_b64_tr_b16 v[174:175], v164 offset:1024
    ds_read_b64_tr_b16 v[176:177], v163 offset:2048
    ds_read_b64_tr_b16 v[178:179], v163 offset:3072
    ds_read_b64_tr_b16 v[180:181], v164 offset:2048
    ds_read_b64_tr_b16 v[182:183], v164 offset:3072
    ds_read_b64_tr_b16 v[184:185], v163 offset:4096
    ds_read_b64_tr_b16 v[186:187], v163 offset:5120
    ds_read_b64_tr_b16 v[188:189], v164 offset:4096
    ds_read_b64_tr_b16 v[190:191], v164 offset:5120
    s_waitcnt lgkmcnt(0)
    ds_read_b64_tr_b16 v[192:193], v163 offset:6144
    ds_read_b64_tr_b16 v[194:195], v163 offset:7168
    ds_read_b64_tr_b16 v[196:197], v164 offset:6144
    ds_read_b64_tr_b16 v[198:199], v164 offset:7168
    ds_read_b64_tr_b16 v[200:201], v163 offset:8192
    ds_read_b64_tr_b16 v[202:203], v163 offset:9216
    ds_read_b64_tr_b16 v[204:205], v164 offset:8192
    ds_read_b64_tr_b16 v[206:207], v164 offset:9216
    ds_read_b64_tr_b16 v[208:209], v163 offset:10240
    ds_read_b64_tr_b16 v[210:211], v163 offset:11264
    ds_read_b64_tr_b16 v[212:213], v164 offset:10240
    ds_read_b64_tr_b16 v[214:215], v164 offset:11264
    s_waitcnt lgkmcnt(0)
    ds_read_b64_tr_b16 v[216:217], v163 offset:12288
    ds_read_b64_tr_b16 v[218:219], v163 offset:13312
    ds_read_b64_tr_b16 v[220:221], v164 offset:12288
    ds_read_b64_tr_b16 v[222:223], v164 offset:13312
    ds_read_b64_tr_b16 v[224:225], v163 offset:14336
    ds_read_b64_tr_b16 v[226:227], v163 offset:15360
    ds_read_b64_tr_b16 v[228:229], v164 offset:14336
    ds_read_b64_tr_b16 v[230:231], v164 offset:15360
    s_waitcnt lgkmcnt(0)
    v_cndmask_b32 v178, v178, v252, s[64:65]
    v_cndmask_b32 v179, v179, v252, s[64:65]
    v_cndmask_b32 v182, v182, v252, s[64:65]
    v_cndmask_b32 v183, v183, v252, s[64:65]
    v_cndmask_b32 v194, v194, v252, s[64:65]
    v_cndmask_b32 v195, v195, v252, s[64:65]
    v_cndmask_b32 v198, v198, v252, s[64:65]
    v_cndmask_b32 v199, v199, v252, s[64:65]
    v_cndmask_b32 v210, v210, v252, s[64:65]
    v_cndmask_b32 v211, v211, v252, s[64:65]
    v_cndmask_b32 v214, v214, v252, s[64:65]
    v_cndmask_b32 v215, v215, v252, s[64:65]
    v_cndmask_b32 v226, v226, v252, s[64:65]
    v_cndmask_b32 v227, v227, v252, s[64:65]
    v_cndmask_b32 v230, v230, v252, s[64:65]
    v_cndmask_b32 v231, v231, v252, s[64:65]
    s_mov_b32 s60, s28
    s_mov_b32 s61, s29
    s_mov_b32 s62, 1605632
    s_mov_b32 s63, 0x20000
    s_mul_i32 s67, s37, 401408
    s_add_u32 s67, s67, s73
    s_add_u32 m0, s66, 0
    s_nop 0
    buffer_load_dwordx4 v161, s[60:63], s67 offen lds
    buffer_load_dwordx4 v162, s[60:63], s67 offen offset:1024 lds
    s_add_u32 s67, s67, 14336
    s_add_u32 m0, s66, 2048
    s_nop 0
    buffer_load_dwordx4 v161, s[60:63], s67 offen lds
    buffer_load_dwordx4 v162, s[60:63], s67 offen offset:1024 lds
    s_add_u32 s67, s67, 14336
    s_add_u32 m0, s66, 4096
    s_nop 0
    buffer_load_dwordx4 v161, s[60:63], s67 offen lds
    buffer_load_dwordx4 v162, s[60:63], s67 offen offset:1024 lds
    s_add_u32 s67, s67, 14336
    s_add_u32 m0, s66, 6144
    s_nop 0
    buffer_load_dwordx4 v161, s[60:63], s67 offen lds
    buffer_load_dwordx4 v162, s[60:63], s67 offen offset:1024 lds
    s_add_u32 s67, s67, 14336
    s_add_u32 m0, s66, 8192
    s_nop 0
    buffer_load_dwordx4 v161, s[60:63], s67 offen lds
    buffer_load_dwordx4 v162, s[60:63], s67 offen offset:1024 lds
    s_add_u32 s67, s67, 14336
    s_add_u32 m0, s66, 10240
    s_nop 0
    buffer_load_dwordx4 v161, s[60:63], s67 offen lds
    buffer_load_dwordx4 v162, s[60:63], s67 offen offset:1024 lds
    s_add_u32 s67, s67, 14336
    s_add_u32 m0, s66, 12288
    s_nop 0
    buffer_load_dwordx4 v161, s[60:63], s67 offen lds
    buffer_load_dwordx4 v162, s[60:63], s67 offen offset:1024 lds
    s_add_u32 s67, s67, 14336
    s_waitcnt vmcnt(0)
    s_cmp_lg_u32 s37, 0
    s_cbranch_scc1 L2_ffn_follow
    v_lshrrev_b32 v248, 2, v1
    v_and_b32 v248, 60, v248
    s_lshr_b32 s78, s74, 2
    s_lshl_b32 s78, s78, 8
    s_add_u32 s78, s78, 4096
    v_add_u32 v248, s78, v248
    s_mov_b32 s78, 262144
    s_mov_b32 s79, 27262976
LP10:
    buffer_load_dword v249, v248, s[48:51], s79 offen sc1
    s_waitcnt vmcnt(0)
    v_cmp_ne_u32 vcc, s100, v249
    s_cbranch_vccz LP10x
    s_sleep 2
    s_sub_u32 s78, s78, 1
    s_cmp_lg_u32 s78, 0
    s_cbranch_scc1 LP10
LP10x:
    v_mov_b32 v248, 163336
    v_mov_b32 v249, s100
    ds_write_b32 v248, v249
    s_branch L2_ffn_go
L2_ffn_follow:
    v_mov_b32 v248, 163336
    s_mov_b32 s78, 1048576
LW11:
    ds_read_b32 v249, v248
    s_waitcnt lgkmcnt(0)
    v_cmp_ne_u32 vcc, s100, v249
    s_cbranch_vccz LW11x
    s_sleep 1
    s_sub_u32 s78, s78, 1
    s_cmp_lg_u32 s78, 0
    s_cbranch_scc1 LW11
LW11x:
L2_ffn_go:
    buffer_load_dwordx4 v[72:75], v160, s[48:51], s68 offen sc1
    buffer_load_dwordx4 v[76:79], v160, s[48:51], s69 offen sc1
    v_add_u32 v160, 1024, v160
    buffer_load_dwordx4 v[80:83], v160, s[48:51], s68 offen sc1
    buffer_load_dwordx4 v[84:87], v160, s[48:51], s69 offen sc1
    v_add_u32 v160, 1024, v160
    buffer_load_dwordx4 v[88:91], v160, s[48:51], s68 offen sc1
    buffer_load_dwordx4 v[92:95], v160, s[48:51], s69 offen sc1
    v_add_u32 v160, 1024, v160
    buffer_load_dwordx4 v[96:99], v160, s[48:51], s68 offen sc1
    buffer_load_dwordx4 v[100:103], v160, s[48:51], s69 offen sc1
    v_add_u32 v160, 1024, v160
    buffer_load_dwordx4 v[104:107], v160, s[48:51], s68 offen sc1
    buffer_load_dwordx4 v[108:111], v160, s[48:51], s69 offen sc1
    v_add_u32 v160, 1024, v160
    buffer_load_dwordx4 v[112:115], v160, s[48:51], s68 offen sc1
    buffer_load_dwordx4 v[116:119], v160, s[48:51], s69 offen sc1
    v_add_u32 v160, 1024, v160
    buffer_load_dwordx4 v[120:123], v160, s[48:51], s68 offen sc1
    buffer_load_dwordx4 v[124:127], v160, s[48:51], s69 offen sc1
    v_add_u32 v160, 1024, v160
    s_mov_b32 s52, s16
    s_mov_b32 s53, s17
    s_mov_b32 s54, 1835008
    s_mov_b32 s55, 0x20000
    s_mov_b32 s56, s30
    s_mov_b32 s57, s31
    s_mov_b32 s58, 896
    s_mov_b32 s59, 0x20000
    v_and_b32 v248, 31, v0
    v_mul_u32_u24 v248, 896, v248
    v_bfe_u32 v249, v0, 5, 1
    v_lshlrev_b32 v249, 3, v249
    v_add_u32 v248, v248, v249
    s_mul_i32 s78, s76, 28672
    s_lshl_b32 s79, s77, 6
    s_add_u32 s78, s78, s79
    ds_read_b64_tr_b16 v[128:129], v163 offset:0
    ds_read_b64_tr_b16 v[130:131], v163 offset:1024
    ds_read_b64_tr_b16 v[132:133], v164 offset:0
    ds_read_b64_tr_b16 v[134:135], v164 offset:1024
    s_setprio 0
    s_waitcnt vmcnt(12)
    s_waitcnt lgkmcnt(0)
    v_mfma_f32_32x32x16_bf16 v[8:23], v[128:131], v[72:75], 0
    ds_read_b64_tr_b16 v[136:137], v163 offset:2048
    ds_read_b64_tr_b16 v[138:139], v163 offset:3072
    v_mfma_f32_32x32x16_bf16 v[24:39], v[132:135], v[72:75], 0
    ds_read_b64_tr_b16 v[140:141], v164 offset:2048
    ds_read_b64_tr_b16 v[142:143], v164 offset:3072
    v_mfma_f32_32x32x16_bf16 v[40:55], v[128:131], v[76:79], 0
    s_add_u32 m0, s66, 0
    s_nop 0
    buffer_load_dwordx4 v161, s[60:63], s67 offen lds
    buffer_load_dwordx4 v162, s[60:63], s67 offen offset:1024 lds
    s_add_u32 s67, s67, 14336
    v_mfma_f32_32x32x16_bf16 v[56:71], v[132:135], v[76:79], 0
    buffer_load_dwordx4 v[72:75], v160, s[48:51], s68 offen sc1
    buffer_load_dwordx4 v[76:79], v160, s[48:51], s69 offen sc1
    v_add_u32 v160, 1024, v160
    s_waitcnt vmcnt(14)
    s_waitcnt lgkmcnt(0)
    v_mfma_f32_32x32x16_bf16 v[8:23], v[136:139], v[80:83], v[8:23]
    ds_read_b64_tr_b16 v[128:129], v163 offset:4096
    ds_read_b64_tr_b16 v[130:131], v163 offset:5120
    v_mfma_f32_32x32x16_bf16 v[24:39], v[140:143], v[80:83], v[24:39]
    ds_read_b64_tr_b16 v[132:133], v164 offset:4096
    ds_read_b64_tr_b16 v[134:135], v164 offset:5120
    v_mfma_f32_32x32x16_bf16 v[40:55], v[136:139], v[84:87], v[40:55]
    s_add_u32 m0, s66, 2048
    s_nop 0
    buffer_load_dwordx4 v161, s[60:63], s67 offen lds
    buffer_load_dwordx4 v162, s[60:63], s67 offen offset:1024 lds
    s_add_u32 s67, s67, 14336
    v_mfma_f32_32x32x16_bf16 v[56:71], v[140:143], v[84:87], v[56:71]
    buffer_load_dwordx4 v[80:83], v160, s[48:51], s68 offen sc1
    buffer_load_dwordx4 v[84:87], v160, s[48:51], s69 offen sc1
    v_add_u32 v160, 1024, v160
    s_waitcnt vmcnt(16)
    s_waitcnt lgkmcnt(0)
    v_mfma_f32_32x32x16_bf16 v[8:23], v[128:131], v[88:91], v[8:23]
    ds_read_b64_tr_b16 v[136:137], v163 offset:6144
    ds_read_b64_tr_b16 v[138:139], v163 offset:7168
    v_mfma_f32_32x32x16_bf16 v[24:39], v[132:135], v[88:91], v[24:39]
    ds_read_b64_tr_b16 v[140:141], v164 offset:6144
    ds_read_b64_tr_b16 v[142:143], v164 offset:7168
    v_mfma_f32_32x32x16_bf16 v[40:55], v[128:131], v[92:95], v[40:55]
    s_add_u32 m0, s66, 4096
    s_nop 0
    buffer_load_dwordx4 v161, s[60:63], s67 offen lds
    buffer_load_dwordx4 v162, s[60:63], s67 offen offset:1024 lds
    s_add_u32 s67, s67, 14336
    v_mfma_f32_32x32x16_bf16 v[56:71], v[132:135], v[92:95], v[56:71]
    buffer_load_dwordx4 v[88:91], v160, s[48:51], s68 offen sc1
    buffer_load_dwordx4 v[92:95], v160, s[48:51], s69 offen sc1
    v_add_u32 v160, 1024, v160
    s_waitcnt vmcnt(18)
    s_waitcnt lgkmcnt(0)
    v_mfma_f32_32x32x16_bf16 v[8:23], v[136:139], v[96:99], v[8:23]
    ds_read_b64_tr_b16 v[128:129], v163 offset:8192
    ds_read_b64_tr_b16 v[130:131], v163 offset:9216
    v_mfma_f32_32x32x16_bf16 v[24:39], v[140:143], v[96:99], v[24:39]
    ds_read_b64_tr_b16 v[132:133], v164 offset:8192
    ds_read_b64_tr_b16 v[134:135], v164 offset:9216
    v_mfma_f32_32x32x16_bf16 v[40:55], v[136:139], v[100:103], v[40:55]
    s_add_u32 m0, s66, 6144
    s_nop 0
    buffer_load_dwordx4 v161, s[60:63], s67 offen lds
    buffer_load_dwordx4 v162, s[60:63], s67 offen offset:1024 lds
    s_add_u32 s67, s67, 14336
    v_mfma_f32_32x32x16_bf16 v[56:71], v[140:143], v[100:103], v[56:71]
    buffer_load_dwordx4 v[96:99], v160, s[48:51], s68 offen sc1
    buffer_load_dwordx4 v[100:103], v160, s[48:51], s69 offen sc1
    v_add_u32 v160, 1024, v160
    s_waitcnt vmcnt(20)
    s_waitcnt lgkmcnt(0)
    v_mfma_f32_32x32x16_bf16 v[8:23], v[128:131], v[104:107], v[8:23]
    ds_read_b64_tr_b16 v[136:137], v163 offset:10240
    ds_read_b64_tr_b16 v[138:139], v163 offset:11264
    v_mfma_f32_32x32x16_bf16 v[24:39], v[132:135], v[104:107], v[24:39]
    ds_read_b64_tr_b16 v[140:141], v164 offset:10240
    ds_read_b64_tr_b16 v[142:143], v164 offset:11264
    v_mfma_f32_32x32x16_bf16 v[40:55], v[128:131], v[108:111], v[40:55]
    s_add_u32 m0, s66, 8192
    s_nop 0
    buffer_load_dwordx4 v161, s[60:63], s67 offen lds
    buffer_load_dwordx4 v162, s[60:63], s67 offen offset:1024 lds
    s_add_u32 s67, s67, 14336
    v_mfma_f32_32x32x16_bf16 v[56:71], v[132:135], v[108:111], v[56:71]
    buffer_load_dwordx4 v[104:107], v160, s[48:51], s68 offen sc1
    buffer_load_dwordx4 v[108:111], v160, s[48:51], s69 offen sc1
    v_add_u32 v160, 1024, v160
    s_waitcnt vmcnt(22)
    s_waitcnt lgkmcnt(0)
    v_mfma_f32_32x32x16_bf16 v[8:23], v[136:139], v[112:115], v[8:23]
    ds_read_b64_tr_b16 v[128:129], v163 offset:12288
    ds_read_b64_tr_b16 v[130:131], v163 offset:13312
    v_mfma_f32_32x32x16_bf16 v[24:39], v[140:143], v[112:115], v[24:39]
    ds_read_b64_tr_b16 v[132:133], v164 offset:12288
    ds_read_b64_tr_b16 v[134:135], v164 offset:13312
    v_mfma_f32_32x32x16_bf16 v[40:55], v[136:139], v[116:119], v[40:55]
    s_add_u32 m0, s66, 10240
    s_nop 0
    buffer_load_dwordx4 v161, s[60:63], s67 offen lds
    buffer_load_dwordx4 v162, s[60:63], s67 offen offset:1024 lds
    s_add_u32 s67, s67, 14336
    v_mfma_f32_32x32x16_bf16 v[56:71], v[140:143], v[116:119], v[56:71]
    buffer_load_dwordx4 v[112:115], v160, s[48:51], s68 offen sc1
    buffer_load_dwordx4 v[116:119], v160, s[48:51], s69 offen sc1
    v_add_u32 v160, 1024, v160
    s_waitcnt vmcnt(22)
    s_waitcnt lgkmcnt(0)
    v_mfma_f32_32x32x16_bf16 v[8:23], v[128:131], v[120:123], v[8:23]
    ds_read_b64_tr_b16 v[136:137], v163 offset:0
    ds_read_b64_tr_b16 v[138:139], v163 offset:1024
    v_mfma_f32_32x32x16_bf16 v[24:39], v[132:135], v[120:123], v[24:39]
    ds_read_b64_tr_b16 v[140:141], v164 offset:0
    ds_read_b64_tr_b16 v[142:143], v164 offset:1024
    v_mfma_f32_32x32x16_bf16 v[40:55], v[128:131], v[124:127], v[40:55]
    s_add_u32 m0, s66, 12288
    s_nop 0
    buffer_load_dwordx4 v161, s[60:63], s67 offen lds
    buffer_load_dwordx4 v162, s[60:63], s67 offen offset:1024 lds
    s_add_u32 s67, s67, 14336
    v_mfma_f32_32x32x16_bf16 v[56:71], v[132:135], v[124:127], v[56:71]
    buffer_load_dwordx4 v[120:123], v160, s[48:51], s68 offen sc1
    buffer_load_dwordx4 v[124:127], v160, s[48:51], s69 offen sc1
    v_add_u32 v160, 1024, v160
    s_waitcnt vmcnt(22)
    s_waitcnt lgkmcnt(0)
    v_mfma_f32_32x32x16_bf16 v[8:23], v[136:139], v[72:75], v[8:23]
    ds_read_b64_tr_b16 v[128:129], v163 offset:2048
    ds_read_b64_tr_b16 v[130:131], v163 offset:3072
    v_mfma_f32_32x32x16_bf16 v[24:39], v[140:143], v[72:75], v[24:39]
    ds_read_b64_tr_b16 v[132:133], v164 offset:2048
    ds_read_b64_tr_b16 v[134:135], v164 offset:3072
    v_mfma_f32_32x32x16_bf16 v[40:55], v[136:139], v[76:79], v[40:55]
    s_add_u32 m0, s66, 0
    s_nop 0
    buffer_load_dwordx4 v161, s[60:63], s67 offen lds
    buffer_load_dwordx4 v162, s[60:63], s67 offen offset:1024 lds
    s_add_u32 s67, s67, 14336
    v_mfma_f32_32x32x16_bf16 v[56:71], v[140:143], v[76:79], v[56:71]
    buffer_load_dwordx4 v[72:75], v160, s[48:51], s68 offen sc1
    buffer_load_dwordx4 v[76:79], v160, s[48:51], s69 offen sc1
    v_add_u32 v160, 1024, v160
    s_waitcnt vmcnt(22)
    s_waitcnt lgkmcnt(0)
    v_mfma_f32_32x32x16_bf16 v[8:23], v[128:131], v[80:83], v[8:23]
    ds_read_b64_tr_b16 v[136:137], v163 offset:4096
    ds_read_b64_tr_b16 v[138:139], v163 offset:5120
    v_mfma_f32_32x32x16_bf16 v[24:39], v[132:135], v[80:83], v[24:39]
    ds_read_b64_tr_b16 v[140:141], v164 offset:4096
    ds_read_b64_tr_b16 v[142:143], v164 offset:5120
    v_mfma_f32_32x32x16_bf16 v[40:55], v[128:131], v[84:87], v[40:55]
    s_add_u32 m0, s66, 2048
    s_nop 0
    buffer_load_dwordx4 v161, s[60:63], s67 offen lds
    buffer_load_dwordx4 v162, s[60:63], s67 offen offset:1024 lds
    s_add_u32 s67, s67, 14336
    v_mfma_f32_32x32x16_bf16 v[56:71], v[132:135], v[84:87], v[56:71]
    buffer_load_dwordx4 v[80:83], v160, s[48:51], s68 offen sc1
    buffer_load_dwordx4 v[84:87], v160, s[48:51], s69 offen sc1
    v_add_u32 v160, 1024, v160
    s_waitcnt vmcnt(22)
    s_waitcnt lgkmcnt(0)
    v_mfma_f32_32x32x16_bf16 v[8:23], v[136:139], v[88:91], v[8:23]
    ds_read_b64_tr_b16 v[128:129], v163 offset:6144
    ds_read_b64_tr_b16 v[130:131], v163 offset:7168
    v_mfma_f32_32x32x16_bf16 v[24:39], v[140:143], v[88:91], v[24:39]
    ds_read_b64_tr_b16 v[132:133], v164 offset:6144
    ds_read_b64_tr_b16 v[134:135], v164 offset:7168
    v_mfma_f32_32x32x16_bf16 v[40:55], v[136:139], v[92:95], v[40:55]
    s_add_u32 m0, s66, 4096
    s_nop 0
    buffer_load_dwordx4 v161, s[60:63], s67 offen lds
    buffer_load_dwordx4 v162, s[60:63], s67 offen offset:1024 lds
    s_add_u32 s67, s67, 14336
    v_mfma_f32_32x32x16_bf16 v[56:71], v[140:143], v[92:95], v[56:71]
    buffer_load_dwordx4 v[88:91], v160, s[48:51], s68 offen sc1
    buffer_load_dwordx4 v[92:95], v160, s[48:51], s69 offen sc1
    v_add_u32 v160, 1024, v160
    s_waitcnt vmcnt(22)
    s_waitcnt lgkmcnt(0)
    v_mfma_f32_32x32x16_bf16 v[8:23], v[128:131], v[96:99], v[8:23]
    ds_read_b64_tr_b16 v[136:137], v163 offset:8192
    ds_read_b64_tr_b16 v[138:139], v163 offset:9216
    v_mfma_f32_32x32x16_bf16 v[24:39], v[132:135], v[96:99], v[24:39]
    ds_read_b64_tr_b16 v[140:141], v164 offset:8192
    ds_read_b64_tr_b16 v[142:143], v164 offset:9216
    v_mfma_f32_32x32x16_bf16 v[40:55], v[128:131], v[100:103], v[40:55]
    s_add_u32 m0, s66, 6144
    s_nop 0
    buffer_load_dwordx4 v161, s[60:63], s67 offen lds
    buffer_load_dwordx4 v162, s[60:63], s67 offen offset:1024 lds
    s_add_u32 s67, s67, 14336
    v_mfma_f32_32x32x16_bf16 v[56:71], v[132:135], v[100:103], v[56:71]
    buffer_load_dwordx4 v[96:99], v160, s[48:51], s68 offen sc1
    buffer_load_dwordx4 v[100:103], v160, s[48:51], s69 offen sc1
    v_add_u32 v160, 1024, v160
    s_waitcnt vmcnt(22)
    s_waitcnt lgkmcnt(0)
    v_mfma_f32_32x32x16_bf16 v[8:23], v[136:139], v[104:107], v[8:23]
    ds_read_b64_tr_b16 v[128:129], v163 offset:10240
    ds_read_b64_tr_b16 v[130:131], v163 offset:11264
    v_mfma_f32_32x32x16_bf16 v[24:39], v[140:143], v[104:107], v[24:39]
    ds_read_b64_tr_b16 v[132:133], v164 offset:10240
    ds_read_b64_tr_b16 v[134:135], v164 offset:11264
    v_mfma_f32_32x32x16_bf16 v[40:55], v[136:139], v[108:111], v[40:55]
    s_add_u32 m0, s66, 8192
    s_nop 0
    buffer_load_dwordx4 v161, s[60:63], s67 offen lds
    buffer_load_dwordx4 v162, s[60:63], s67 offen offset:1024 lds
    s_add_u32 s67, s67, 14336
    v_mfma_f32_32x32x16_bf16 v[56:71], v[140:143], v[108:111], v[56:71]
    buffer_load_dwordx4 v[104:107], v160, s[48:51], s68 offen sc1
    buffer_load_dwordx4 v[108:111], v160, s[48:51], s69 offen sc1
    v_add_u32 v160, 1024, v160
    s_waitcnt vmcnt(22)
    s_waitcnt lgkmcnt(0)
    v_mfma_f32_32x32x16_bf16 v[8:23], v[128:131], v[112:115], v[8:23]
    ds_read_b64_tr_b16 v[136:137], v163 offset:12288
    ds_read_b64_tr_b16 v[138:139], v163 offset:13312
    v_mfma_f32_32x32x16_bf16 v[24:39], v[132:135], v[112:115], v[24:39]
    ds_read_b64_tr_b16 v[140:141], v164 offset:12288
    ds_read_b64_tr_b16 v[142:143], v164 offset:13312
    v_mfma_f32_32x32x16_bf16 v[40:55], v[128:131], v[116:119], v[40:55]
    s_add_u32 m0, s66, 10240
    s_nop 0
    buffer_load_dwordx4 v161, s[60:63], s67 offen lds
    buffer_load_dwordx4 v162, s[60:63], s67 offen offset:1024 lds
    s_add_u32 s67, s67, 14336
    v_mfma_f32_32x32x16_bf16 v[56:71], v[132:135], v[116:119], v[56:71]
    buffer_load_dwordx4 v[112:115], v160, s[48:51], s68 offen sc1
    buffer_load_dwordx4 v[116:119], v160, s[48:51], s69 offen sc1
    v_add_u32 v160, 1024, v160
    s_waitcnt vmcnt(22)
    s_waitcnt lgkmcnt(0)
    v_mfma_f32_32x32x16_bf16 v[8:23], v[136:139], v[120:123], v[8:23]
    ds_read_b64_tr_b16 v[128:129], v163 offset:0
    ds_read_b64_tr_b16 v[130:131], v163 offset:1024
    v_mfma_f32_32x32x16_bf16 v[24:39], v[140:143], v[120:123], v[24:39]
    ds_read_b64_tr_b16 v[132:133], v164 offset:0
    ds_read_b64_tr_b16 v[134:135], v164 offset:1024
    v_mfma_f32_32x32x16_bf16 v[40:55], v[136:139], v[124:127], v[40:55]
    s_add_u32 m0, s66, 12288
    s_nop 0
    buffer_load_dwordx4 v161, s[60:63], s67 offen lds
    buffer_load_dwordx4 v162, s[60:63], s67 offen offset:1024 lds
    s_add_u32 s67, s67, 14336
    v_mfma_f32_32x32x16_bf16 v[56:71], v[140:143], v[124:127], v[56:71]
    buffer_load_dwordx4 v[120:123], v160, s[48:51], s68 offen sc1
    buffer_load_dwordx4 v[124:127], v160, s[48:51], s69 offen sc1
    v_add_u32 v160, 1024, v160
    s_waitcnt vmcnt(22)
    s_waitcnt lgkmcnt(0)
    v_mfma_f32_32x32x16_bf16 v[8:23], v[128:131], v[72:75], v[8:23]
    ds_read_b64_tr_b16 v[136:137], v163 offset:2048
    ds_read_b64_tr_b16 v[138:139], v163 offset:3072
    v_mfma_f32_32x32x16_bf16 v[24:39], v[132:135], v[72:75], v[24:39]
    ds_read_b64_tr_b16 v[140:141], v164 offset:2048
    ds_read_b64_tr_b16 v[142:143], v164 offset:3072
    v_mfma_f32_32x32x16_bf16 v[40:55], v[128:131], v[76:79], v[40:55]
    s_add_u32 m0, s66, 0
    s_nop 0
    buffer_load_dwordx4 v161, s[60:63], s67 offen lds
    buffer_load_dwordx4 v162, s[60:63], s67 offen offset:1024 lds
    s_add_u32 s67, s67, 14336
    v_mfma_f32_32x32x16_bf16 v[56:71], v[132:135], v[76:79], v[56:71]
    buffer_load_dwordx4 v[72:75], v160, s[48:51], s68 offen sc1
    buffer_load_dwordx4 v[76:79], v160, s[48:51], s69 offen sc1
    v_add_u32 v160, 1024, v160
    s_waitcnt vmcnt(22)
    s_waitcnt lgkmcnt(0)
    v_mfma_f32_32x32x16_bf16 v[8:23], v[136:139], v[80:83], v[8:23]
    ds_read_b64_tr_b16 v[128:129], v163 offset:4096
    ds_read_b64_tr_b16 v[130:131], v163 offset:5120
    v_mfma_f32_32x32x16_bf16 v[24:39], v[140:143], v[80:83], v[24:39]
    ds_read_b64_tr_b16 v[132:133], v164 offset:4096
    ds_read_b64_tr_b16 v[134:135], v164 offset:5120
    v_mfma_f32_32x32x16_bf16 v[40:55], v[136:139], v[84:87], v[40:55]
    s_add_u32 m0, s66, 2048
    s_nop 0
    buffer_load_dwordx4 v161, s[60:63], s67 offen lds
    buffer_load_dwordx4 v162, s[60:63], s67 offen offset:1024 lds
    s_add_u32 s67, s67, 14336
    v_mfma_f32_32x32x16_bf16 v[56:71], v[140:143], v[84:87], v[56:71]
    buffer_load_dwordx4 v[80:83], v160, s[48:51], s68 offen sc1
    buffer_load_dwordx4 v[84:87], v160, s[48:51], s69 offen sc1
    v_add_u32 v160, 1024, v160
    s_waitcnt vmcnt(22)
    s_waitcnt lgkmcnt(0)
    v_mfma_f32_32x32x16_bf16 v[8:23], v[128:131], v[88:91], v[8:23]
    ds_read_b64_tr_b16 v[136:137], v163 offset:6144
    ds_read_b64_tr_b16 v[138:139], v163 offset:7168
    v_mfma_f32_32x32x16_bf16 v[24:39], v[132:135], v[88:91], v[24:39]
    ds_read_b64_tr_b16 v[140:141], v164 offset:6144
    ds_read_b64_tr_b16 v[142:143], v164 offset:7168
    v_mfma_f32_32x32x16_bf16 v[40:55], v[128:131], v[92:95], v[40:55]
    s_add_u32 m0, s66, 4096
    s_nop 0
    buffer_load_dwordx4 v161, s[60:63], s67 offen lds
    buffer_load_dwordx4 v162, s[60:63], s67 offen offset:1024 lds
    s_add_u32 s67, s67, 14336
    v_mfma_f32_32x32x16_bf16 v[56:71], v[132:135], v[92:95], v[56:71]
    buffer_load_dwordx4 v[88:91], v160, s[48:51], s68 offen sc1
    buffer_load_dwordx4 v[92:95], v160, s[48:51], s69 offen sc1
    v_add_u32 v160, 1024, v160
    s_waitcnt vmcnt(22)
    s_waitcnt lgkmcnt(0)
    v_mfma_f32_32x32x16_bf16 v[8:23], v[136:139], v[96:99], v[8:23]
    ds_read_b64_tr_b16 v[128:129], v163 offset:8192
    ds_read_b64_tr_b16 v[130:131], v163 offset:9216
    v_mfma_f32_32x32x16_bf16 v[24:39], v[140:143], v[96:99], v[24:39]
    ds_read_b64_tr_b16 v[132:133], v164 offset:8192
    ds_read_b64_tr_b16 v[134:135], v164 offset:9216
    v_mfma_f32_32x32x16_bf16 v[40:55], v[136:139], v[100:103], v[40:55]
    s_add_u32 m0, s66, 6144
    s_nop 0
    buffer_load_dwordx4 v161, s[60:63], s67 offen lds
    buffer_load_dwordx4 v162, s[60:63], s67 offen offset:1024 lds
    s_add_u32 s67, s67, 14336
    v_mfma_f32_32x32x16_bf16 v[56:71], v[140:143], v[100:103], v[56:71]
    buffer_load_dwordx4 v[96:99], v160, s[48:51], s68 offen sc1
    buffer_load_dwordx4 v[100:103], v160, s[48:51], s69 offen sc1
    v_add_u32 v160, 1024, v160
    s_waitcnt vmcnt(22)
    s_waitcnt lgkmcnt(0)
    v_mfma_f32_32x32x16_bf16 v[8:23], v[128:131], v[104:107], v[8:23]
    ds_read_b64_tr_b16 v[136:137], v163 offset:10240
    ds_read_b64_tr_b16 v[138:139], v163 offset:11264
    v_mfma_f32_32x32x16_bf16 v[24:39], v[132:135], v[104:107], v[24:39]
    ds_read_b64_tr_b16 v[140:141], v164 offset:10240
    ds_read_b64_tr_b16 v[142:143], v164 offset:11264
    v_mfma_f32_32x32x16_bf16 v[40:55], v[128:131], v[108:111], v[40:55]
    s_add_u32 m0, s66, 8192
    s_nop 0
    buffer_load_dwordx4 v161, s[60:63], s67 offen lds
    buffer_load_dwordx4 v162, s[60:63], s67 offen offset:1024 lds
    s_add_u32 s67, s67, 14336
    v_mfma_f32_32x32x16_bf16 v[56:71], v[132:135], v[108:111], v[56:71]
    buffer_load_dwordx4 v[104:107], v160, s[48:51], s68 offen sc1
    buffer_load_dwordx4 v[108:111], v160, s[48:51], s69 offen sc1
    v_add_u32 v160, 1024, v160
    s_waitcnt vmcnt(22)
    s_waitcnt lgkmcnt(0)
    v_mfma_f32_32x32x16_bf16 v[8:23], v[136:139], v[112:115], v[8:23]
    ds_read_b64_tr_b16 v[128:129], v163 offset:12288
    ds_read_b64_tr_b16 v[130:131], v163 offset:13312
    v_mfma_f32_32x32x16_bf16 v[24:39], v[140:143], v[112:115], v[24:39]
    ds_read_b64_tr_b16 v[132:133], v164 offset:12288
    ds_read_b64_tr_b16 v[134:135], v164 offset:13312
    v_mfma_f32_32x32x16_bf16 v[40:55], v[136:139], v[116:119], v[40:55]
    s_add_u32 m0, s66, 10240
    s_nop 0
    buffer_load_dwordx4 v161, s[60:63], s67 offen lds
    buffer_load_dwordx4 v162, s[60:63], s67 offen offset:1024 lds
    s_add_u32 s67, s67, 14336
    v_mfma_f32_32x32x16_bf16 v[56:71], v[140:143], v[116:119], v[56:71]
    buffer_load_dwordx4 v[112:115], v160, s[48:51], s68 offen sc1
    buffer_load_dwordx4 v[116:119], v160, s[48:51], s69 offen sc1
    v_add_u32 v160, 1024, v160
    s_waitcnt vmcnt(22)
    s_waitcnt lgkmcnt(0)
    v_mfma_f32_32x32x16_bf16 v[8:23], v[128:131], v[120:123], v[8:23]
    ds_read_b64_tr_b16 v[136:137], v163 offset:0
    ds_read_b64_tr_b16 v[138:139], v163 offset:1024
    v_mfma_f32_32x32x16_bf16 v[24:39], v[132:135], v[120:123], v[24:39]
    ds_read_b64_tr_b16 v[140:141], v164 offset:0
    ds_read_b64_tr_b16 v[142:143], v164 offset:1024
    v_mfma_f32_32x32x16_bf16 v[40:55], v[128:131], v[124:127], v[40:55]
    s_add_u32 m0, s66, 12288
    s_nop 0
    buffer_load_dwordx4 v161, s[60:63], s67 offen lds
    buffer_load_dwordx4 v162, s[60:63], s67 offen offset:1024 lds
    s_add_u32 s67, s67, 14336
    v_mfma_f32_32x32x16_bf16 v[56:71], v[132:135], v[124:127], v[56:71]
    buffer_load_dwordx4 v[120:123], v160, s[48:51], s68 offen sc1
    buffer_load_dwordx4 v[124:127], v160, s[48:51], s69 offen sc1
    v_add_u32 v160, 1024, v160
    s_waitcnt vmcnt(22)
    s_waitcnt lgkmcnt(0)
    v_mfma_f32_32x32x16_bf16 v[8:23], v[136:139], v[72:75], v[8:23]
    ds_read_b64_tr_b16 v[128:129], v163 offset:2048
    ds_read_b64_tr_b16 v[130:131], v163 offset:3072
    v_mfma_f32_32x32x16_bf16 v[24:39], v[140:143], v[72:75], v[24:39]
    ds_read_b64_tr_b16 v[132:133], v164 offset:2048
    ds_read_b64_tr_b16 v[134:135], v164 offset:3072
    v_mfma_f32_32x32x16_bf16 v[40:55], v[136:139], v[76:79], v[40:55]
    v_mfma_f32_32x32x16_bf16 v[56:71], v[140:143], v[76:79], v[56:71]
    buffer_load_dwordx2 v[144:145], v248, s[52:55], s78 offen offset:0
    buffer_load_dwordx2 v[146:147], v248, s[52:55], s78 offen offset:16
    buffer_load_dwordx2 v[148:149], v248, s[52:55], s78 offen offset:32
    buffer_load_dwordx2 v[150:151], v248, s[52:55], s78 offen offset:48
    buffer_load_dwordx2 v[152:153], v249, s[56:59], s79 offen offset:0
    buffer_load_dwordx2 v[154:155], v249, s[56:59], s79 offen offset:16
    buffer_load_dwordx2 v[156:157], v249, s[56:59], s79 offen offset:32
    buffer_load_dwordx2 v[158:159], v249, s[56:59], s79 offen offset:48
    s_waitcnt vmcnt(26)
    s_waitcnt lgkmcnt(0)
    v_mfma_f32_32x32x16_bf16 v[8:23], v[128:131], v[80:83], v[8:23]
    ds_read_b64_tr_b16 v[136:137], v163 offset:4096
    ds_read_b64_tr_b16 v[138:139], v163 offset:5120
    v_mfma_f32_32x32x16_bf16 v[24:39], v[132:135], v[80:83], v[24:39]
    ds_read_b64_tr_b16 v[140:141], v164 offset:4096
    ds_read_b64_tr_b16 v[142:143], v164 offset:5120
    v_mfma_f32_32x32x16_bf16 v[40:55], v[128:131], v[84:87], v[40:55]
    v_mfma_f32_32x32x16_bf16 v[56:71], v[132:135], v[84:87], v[56:71]
    s_waitcnt vmcnt(22)
    s_waitcnt lgkmcnt(0)
    v_mfma_f32_32x32x16_bf16 v[8:23], v[136:139], v[88:91], v[8:23]
    ds_read_b64_tr_b16 v[128:129], v163 offset:6144
    ds_read_b64_tr_b16 v[130:131], v163 offset:7168
    v_mfma_f32_32x32x16_bf16 v[24:39], v[140:143], v[88:91], v[24:39]
    ds_read_b64_tr_b16 v[132:133], v164 offset:6144
    ds_read_b64_tr_b16 v[134:135], v164 offset:7168
    v_mfma_f32_32x32x16_bf16 v[40:55], v[136:139], v[92:95], v[40:55]
    v_mfma_f32_32x32x16_bf16 v[56:71], v[140:143], v[92:95], v[56:71]
    s_waitcnt vmcnt(18)
    s_waitcnt lgkmcnt(0)
    v_mfma_f32_32x32x16_bf16 v[8:23], v[128:131], v[96:99], v[8:23]
    ds_read_b64_tr_b16 v[136:137], v163 offset:8192
    ds_read_b64_tr_b16 v[138:139], v163 offset:9216
    v_mfma_f32_32x32x16_bf16 v[24:39], v[132:135], v[96:99], v[24:39]
    ds_read_b64_tr_b16 v[140:141], v164 offset:8192
    ds_read_b64_tr_b16 v[142:143], v164 offset:9216
    v_mfma_f32_32x32x16_bf16 v[40:55], v[128:131], v[100:103], v[40:55]
    v_mfma_f32_32x32x16_bf16 v[56:71], v[132:135], v[100:103], v[56:71]
    s_waitcnt vmcnt(14)
    s_waitcnt lgkmcnt(0)
    v_mfma_f32_32x32x16_bf16 v[8:23], v[136:139], v[104:107], v[8:23]
    ds_read_b64_tr_b16 v[128:129], v163 offset:10240
    ds_read_b64_tr_b16 v[130:131], v163 offset:11264
    v_mfma_f32_32x32x16_bf16 v[24:39], v[140:143], v[104:107], v[24:39]
    ds_read_b64_tr_b16 v[132:133], v164 offset:10240
    ds_read_b64_tr_b16 v[134:135], v164 offset:11264
    v_mfma_f32_32x32x16_bf16 v[40:55], v[136:139], v[108:111], v[40:55]
    v_mfma_f32_32x32x16_bf16 v[56:71], v[140:143], v[108:111], v[56:71]
    s_waitcnt vmcnt(10)
    s_waitcnt lgkmcnt(0)
    v_mfma_f32_32x32x16_bf16 v[8:23], v[128:131], v[112:115], v[8:23]
    ds_read_b64_tr_b16 v[136:137], v163 offset:12288
    ds_read_b64_tr_b16 v[138:139], v163 offset:13312
    v_mfma_f32_32x32x16_bf16 v[24:39], v[132:135], v[112:115], v[24:39]
    ds_read_b64_tr_b16 v[140:141], v164 offset:12288
    ds_read_b64_tr_b16 v[142:143], v164 offset:13312
    v_mfma_f32_32x32x16_bf16 v[40:55], v[128:131], v[116:119], v[40:55]
    v_mfma_f32_32x32x16_bf16 v[56:71], v[132:135], v[116:119], v[56:71]
    s_waitcnt vmcnt(8)
    s_waitcnt lgkmcnt(0)
    v_mfma_f32_32x32x16_bf16 v[8:23], v[136:139], v[120:123], v[8:23]
    v_mfma_f32_32x32x16_bf16 v[24:39], v[140:143], v[120:123], v[24:39]
    v_mfma_f32_32x32x16_bf16 v[40:55], v[136:139], v[124:127], v[40:55]
    v_mfma_f32_32x32x16_bf16 v[56:71], v[140:143], v[124:127], v[56:71]
    s_setprio 2
    s_waitcnt vmcnt(0)
    v_lshlrev_b32 v232, 16, v144
    v_and_b32 v233, 0xffff0000, v144
    v_lshlrev_b32 v252, 16, v152
    v_and_b32 v253, 0xffff0000, v152
    v_add_f32 v232, v232, v252
    v_add_f32 v233, v233, v253
    v_lshlrev_b32 v234, 16, v145
    v_and_b32 v235, 0xffff0000, v145
    v_lshlrev_b32 v252, 16, v153
    v_and_b32 v253, 0xffff0000, v153
    v_add_f32 v234, v234, v252
    v_add_f32 v235, v235, v253
    v_lshlrev_b32 v236, 16, v146
    v_and_b32 v237, 0xffff0000, v146
    v_lshlrev_b32 v252, 16, v154
    v_and_b32 v253, 0xffff0000, v154
    v_add_f32 v236, v236, v252
    v_add_f32 v237, v237, v253
    v_lshlrev_b32 v238, 16, v147
    v_and_b32 v239, 0xffff0000, v147
    v_lshlrev_b32 v252, 16, v155
    v_and_b32 v253, 0xffff0000, v155
    v_add_f32 v238, v238, v252
    v_add_f32 v239, v239, v253
    v_lshlrev_b32 v240, 16, v148
    v_and_b32 v241, 0xffff0000, v148
    v_lshlrev_b32 v252, 16, v156
    v_and_b32 v253, 0xffff0000, v156
    v_add_f32 v240, v240, v252
    v_add_f32 v241, v241, v253
    v_lshlrev_b32 v242, 16, v149
    v_and_b32 v243, 0xffff0000, v149
    v_lshlrev_b32 v252, 16, v157
    v_and_b32 v253, 0xffff0000, v157
    v_add_f32 v242, v242, v252
    v_add_f32 v243, v243, v253
    v_lshlrev_b32 v244, 16, v150
    v_and_b32 v245, 0xffff0000, v150
    v_lshlrev_b32 v252, 16, v158
    v_and_b32 v253, 0xffff0000, v158
    v_add_f32 v244, v244, v252
    v_add_f32 v245, v245, v253
    v_lshlrev_b32 v246, 16, v151
    v_and_b32 v247, 0xffff0000, v151
    v_lshlrev_b32 v252, 16, v159
    v_and_b32 v253, 0xffff0000, v159
    v_add_f32 v246, v246, v252
    v_add_f32 v247, v247, v253
    s_cmp_lg_u32 s37, 0
    s_cbranch_scc1 L2_o_follow
    v_lshrrev_b32 v250, 2, v1
    v_and_b32 v250, 60, v250
    s_lshr_b32 s70, s74, 2
    s_lshl_b32 s70, s70, 8
    s_add_u32 s70, s70, 8192
    v_add_u32 v250, s70, v250
    s_mov_b32 s70, 262144
    s_mov_b32 s71, 27262976
LP12:
    buffer_load_dword v251, v250, s[48:51], s71 offen sc1
    s_waitcnt vmcnt(0)
    v_cmp_ne_u32 vcc, s100, v251
    s_cbranch_vccz LP12x
    s_sleep 2
    s_sub_u32 s70, s70, 1
    s_cmp_lg_u32 s70, 0
    s_cbranch_scc1 LP12
LP12x:
    v_mov_b32 v250, 163344
    v_mov_b32 v251, s100
    ds_write_b32 v250, v251
    s_branch L2_o_go
L2_o_follow:
    v_mov_b32 v250, 163344
    s_mov_b32 s70, 1048576
LW13:
    ds_read_b32 v251, v250
    s_waitcnt lgkmcnt(0)
    v_cmp_ne_u32 vcc, s100, v251
    s_cbranch_vccz LW13x
    s_sleep 1
    s_sub_u32 s70, s70, 1
    s_cmp_lg_u32 s70, 0
    s_cbranch_scc1 LW13
LW13x:
L2_o_go:
    s_lshl_b32 s70, s74, 15
    s_lshl_b32 s71, s37, 13
    s_add_u32 s70, s70, s71
    s_add_u32 s70, s70, 16777216
    s_add_u32 s71, s70, 32768
    v_add_u32 v250, 4096, v1
    buffer_load_dwordx4 v[72:75], v1, s[48:51], s70 offen offset:0 sc1
    buffer_load_dwordx4 v[76:79], v1, s[48:51], s71 offen offset:0 sc1
    buffer_load_dwordx4 v[80:83], v1, s[48:51], s70 offen offset:1024 sc1
    buffer_load_dwordx4 v[84:87], v1, s[48:51], s71 offen offset:1024 sc1
    buffer_load_dwordx4 v[88:91], v1, s[48:51], s70 offen offset:2048 sc1
    buffer_load_dwordx4 v[92:95], v1, s[48:51], s71 offen offset:2048 sc1
    buffer_load_dwordx4 v[96:99], v1, s[48:51], s70 offen offset:3072 sc1
    buffer_load_dwordx4 v[100:103], v1, s[48:51], s71 offen offset:3072 sc1
    buffer_load_dwordx4 v[104:107], v250, s[48:51], s70 offen offset:0 sc1
    buffer_load_dwordx4 v[108:111], v250, s[48:51], s71 offen offset:0 sc1
    buffer_load_dwordx4 v[112:115], v250, s[48:51], s70 offen offset:1024 sc1
    buffer_load_dwordx4 v[116:119], v250, s[48:51], s71 offen offset:1024 sc1
    buffer_load_dwordx4 v[120:123], v250, s[48:51], s70 offen offset:2048 sc1
    buffer_load_dwordx4 v[124:127], v250, s[48:51], s71 offen offset:2048 sc1
    buffer_load_dwordx4 v[128:131], v250, s[48:51], s70 offen offset:3072 sc1
    buffer_load_dwordx4 v[132:135], v250, s[48:51], s71 offen offset:3072 sc1
    s_waitcnt vmcnt(14)
    v_mfma_f32_32x32x16_bf16 v[8:23], v[168:171], v[72:75], v[8:23]
    v_mfma_f32_32x32x16_bf16 v[24:39], v[172:175], v[72:75], v[24:39]
    v_mfma_f32_32x32x16_bf16 v[40:55], v[168:171], v[76:79], v[40:55]
    v_mfma_f32_32x32x16_bf16 v[56:71], v[172:175], v[76:79], v[56:71]
    s_waitcnt vmcnt(12)
    v_mfma_f32_32x32x16_bf16 v[8:23], v[176:179], v[80:83], v[8:23]
    v_mfma_f32_32x32x16_bf16 v[24:39], v[180:183], v[80:83], v[24:39]
    v_mfma_f32_32x32x16_bf16 v[40:55], v[176:179], v[84:87], v[40:55]
    v_mfma_f32_32x32x16_bf16 v[56:71], v[180:183], v[84:87], v[56:71]
    s_waitcnt vmcnt(10)
    v_mfma_f32_32x32x16_bf16 v[8:23], v[184:187], v[88:91], v[8:23]
    v_mfma_f32_32x32x16_bf16 v[24:39], v[188:191], v[88:91], v[24:39]
    v_mfma_f32_32x32x16_bf16 v[40:55], v[184:187], v[92:95], v[40:55]
    v_mfma_f32_32x32x16_bf16 v[56:71], v[188:191], v[92:95], v[56:71]
    s_waitcnt vmcnt(8)
    v_mfma_f32_32x32x16_bf16 v[8:23], v[192:195], v[96:99], v[8:23]
    v_mfma_f32_32x32x16_bf16 v[24:39], v[196:199], v[96:99], v[24:39]
    v_mfma_f32_32x32x16_bf16 v[40:55], v[192:195], v[100:103], v[40:55]
    v_mfma_f32_32x32x16_bf16 v[56:71], v[196:199], v[100:103], v[56:71]
    s_waitcnt vmcnt(6)
    v_mfma_f32_32x32x16_bf16 v[8:23], v[200:203], v[104:107], v[8:23]
    v_mfma_f32_32x32x16_bf16 v[24:39], v[204:207], v[104:107], v[24:39]
    v_mfma_f32_32x32x16_bf16 v[40:55], v[200:203], v[108:111], v[40:55]
    v_mfma_f32_32x32x16_bf16 v[56:71], v[204:207], v[108:111], v[56:71]
    s_waitcnt vmcnt(4)
    v_mfma_f32_32x32x16_bf16 v[8:23], v[208:211], v[112:115], v[8:23]
    v_mfma_f32_32x32x16_bf16 v[24:39], v[212:215], v[112:115], v[24:39]
    v_mfma_f32_32x32x16_bf16 v[40:55], v[208:211], v[116:119], v[40:55]
    v_mfma_f32_32x32x16_bf16 v[56:71], v[212:215], v[116:119], v[56:71]
    s_waitcnt vmcnt(2)
    v_mfma_f32_32x32x16_bf16 v[8:23], v[216:219], v[120:123], v[8:23]
    v_mfma_f32_32x32x16_bf16 v[24:39], v[220:223], v[120:123], v[24:39]
    v_mfma_f32_32x32x16_bf16 v[40:55], v[216:219], v[124:127], v[40:55]
    v_mfma_f32_32x32x16_bf16 v[56:71], v[220:223], v[124:127], v[56:71]
    s_waitcnt vmcnt(0)
    v_mfma_f32_32x32x16_bf16 v[8:23], v[224:227], v[128:131], v[8:23]
    v_mfma_f32_32x32x16_bf16 v[24:39], v[228:231], v[128:131], v[24:39]
    v_mfma_f32_32x32x16_bf16 v[40:55], v[224:227], v[132:135], v[40:55]
    v_mfma_f32_32x32x16_bf16 v[56:71], v[228:231], v[132:135], v[56:71]
    v_add_u32 v250, s66, v1
    s_nop 7
    s_cmp_eq_u32 s37, 0
    s_cbranch_scc1 L2_fw0
    ds_write_b128 v250, v[8:11] offset:0
    ds_write_b128 v250, v[12:15] offset:1024
    ds_write_b128 v250, v[16:19] offset:2048
    ds_write_b128 v250, v[20:23] offset:3072
L2_fw0:
    s_cmp_eq_u32 s37, 1
    s_cbranch_scc1 L2_fw1
    ds_write_b128 v250, v[24:27] offset:4096
    ds_write_b128 v250, v[28:31] offset:5120
    ds_write_b128 v250, v[32:35] offset:6144
    ds_write_b128 v250, v[36:39] offset:7168
L2_fw1:
    s_cmp_eq_u32 s37, 2
    s_cbranch_scc1 L2_fw2
    ds_write_b128 v250, v[40:43] offset:8192
    ds_write_b128 v250, v[44:47] offset:9216
    ds_write_b128 v250, v[48:51] offset:10240
    ds_write_b128 v250, v[52:55] offset:11264
L2_fw2:
    s_nop 3
    s_cmp_eq_u32 s37, 3
    s_cbranch_scc1 L2_fw3
    ds_write_b128 v250, v[56:59] offset:12288
    ds_write_b128 v250, v[60:63] offset:13312
    ds_write_b128 v250, v[64:67] offset:14336
    ds_write_b128 v250, v[68:71] offset:15360
L2_fw3:
    s_waitcnt lgkmcnt(0)
    s_barrier
    s_lshl_b32 s70, s37, 12
    s_add_u32 s70, s70, 65536
    v_add_u32 v250, s70, v1
    s_cmp_eq_u32 s37, 0
    s_cbranch_scc1 L2_fr0
    ds_read_b128 v[8:11], v250 offset:0
    ds_read_b128 v[12:15], v250 offset:1024
    ds_read_b128 v[16:19], v250 offset:2048
    ds_read_b128 v[20:23], v250 offset:3072
L2_fr0:
    s_cmp_eq_u32 s37, 1
    s_cbranch_scc1 L2_fr1
    ds_read_b128 v[24:27], v250 offset:16384
    ds_read_b128 v[28:31], v250 offset:17408
    ds_read_b128 v[32:35], v250 offset:18432
    ds_read_b128 v[36:39], v250 offset:19456
L2_fr1:
    s_cmp_eq_u32 s37, 2
    s_cbranch_scc1 L2_fr2
    ds_read_b128 v[40:43], v250 offset:32768
    ds_read_b128 v[44:47], v250 offset:33792
    ds_read_b128 v[48:51], v250 offset:34816
    ds_read_b128 v[52:55], v250 offset:35840
L2_fr2:
    s_cmp_eq_u32 s37, 3
    s_cbranch_scc1 L2_fr3
    ds_read_b128 v[56:59], v250 offset:49152
    ds_read_b128 v[60:63], v250 offset:50176
    ds_read_b128 v[64:67], v250 offset:51200
    ds_read_b128 v[68:71], v250 offset:52224
L2_fr3:
    v_and_b32 v251, 31, v0
    v_mul_u32_u24 v251, 896, v251
    v_bfe_u32 v252, v0, 5, 1
    v_lshlrev_b32 v252, 4, v252
    v_add_u32 v251, v251, v252
    s_mul_i32 s70, s76, 28672
    s_lshl_b32 s71, s77, 6
    s_add_u32 s70, s70, s71
    s_mov_b32 s40, s88
    s_mov_b32 s41, s89
    s_mov_b32 s42, 1835008
    s_mov_b32 s43, 0x20000
    s_waitcnt lgkmcnt(0)
    v_add_f32 v8, v8, v24
    v_add_f32 v40, v40, v56
    v_add_f32 v9, v9, v25
    v_add_f32 v41, v41, v57
    v_add_f32 v10, v10, v26
    v_add_f32 v42, v42, v58
    v_add_f32 v11, v11, v27
    v_add_f32 v43, v43, v59
    v_add_f32 v12, v12, v28
    v_add_f32 v44, v44, v60
    v_add_f32 v13, v13, v29
    v_add_f32 v45, v45, v61
    v_add_f32 v14, v14, v30
    v_add_f32 v46, v46, v62
    v_add_f32 v15, v15, v31
    v_add_f32 v47, v47, v63
    v_add_f32 v16, v16, v32
    v_add_f32 v48, v48, v64
    v_add_f32 v17, v17, v33
    v_add_f32 v49, v49, v65
    v_add_f32 v18, v18, v34
    v_add_f32 v50, v50, v66
    v_add_f32 v19, v19, v35
    v_add_f32 v51, v51, v67
    v_add_f32 v20, v20, v36
    v_add_f32 v52, v52, v68
    v_add_f32 v21, v21, v37
    v_add_f32 v53, v53, v69
    v_add_f32 v22, v22, v38
    v_add_f32 v54, v54, v70
    v_add_f32 v23, v23, v39
    v_add_f32 v55, v55, v71
    v_add_f32 v8, v8, v40
    v_add_f32 v9, v9, v41
    v_add_f32 v10, v10, v42
    v_add_f32 v11, v11, v43
    v_add_f32 v12, v12, v44
    v_add_f32 v13, v13, v45
    v_add_f32 v14, v14, v46
    v_add_f32 v15, v15, v47
    v_add_f32 v16, v16, v48
    v_add_f32 v17, v17, v49
    v_add_f32 v18, v18, v50
    v_add_f32 v19, v19, v51
    v_add_f32 v20, v20, v52
    v_add_f32 v21, v21, v53
    v_add_f32 v22, v22, v54
    v_add_f32 v23, v23, v55
    v_add_f32 v8, v8, v232
    v_add_f32 v9, v9, v233
    v_add_f32 v10, v10, v234
    v_add_f32 v11, v11, v235
    v_add_f32 v12, v12, v236
    v_add_f32 v13, v13, v237
    v_add_f32 v14, v14, v238
    v_add_f32 v15, v15, v239
    v_add_f32 v16, v16, v240
    v_add_f32 v17, v17, v241
    v_add_f32 v18, v18, v242
    v_add_f32 v19, v19, v243
    v_add_f32 v20, v20, v244
    v_add_f32 v21, v21, v245
    v_add_f32 v22, v22, v246
    v_add_f32 v23, v23, v247
    v_cvt_pk_bf16_f32 v72, v8, v9
    v_cvt_pk_bf16_f32 v73, v10, v11
    v_cvt_pk_bf16_f32 v74, v12, v13
    v_cvt_pk_bf16_f32 v75, v14, v15
    v_cvt_pk_bf16_f32 v76, v16, v17
    v_cvt_pk_bf16_f32 v77, v18, v19
    v_cvt_pk_bf16_f32 v78, v20, v21
    v_cvt_pk_bf16_f32 v79, v22, v23
    s_nop 1
    v_permlane32_swap_b32 v72, v74
    v_permlane32_swap_b32 v73, v75
    v_permlane32_swap_b32 v76, v78
    v_permlane32_swap_b32 v77, v79
    buffer_store_dwordx4 v[72:75], v251, s[40:43], s70 offen
    buffer_store_dwordx4 v[76:79], v251, s[40:43], s70 offen offset:32
    s_endpgm
L2_ffn_none:
    s_endpgm
L_CODE_END:
.section .rodata,"a"
.p2align 6
.amdhsa_kernel parallel_sum__mha_block__dense_activation_squared_relu__prompt_kernel
  .amdhsa_next_free_vgpr 256
  .amdhsa_next_free_sgpr 102
  .amdhsa_accum_offset 256
  .amdhsa_group_segment_fixed_size 0
  .amdhsa_kernarg_size 88
  .amdhsa_user_sgpr_count 2
  .amdhsa_user_sgpr_kernarg_segment_ptr 1
  .amdhsa_system_sgpr_workgroup_id_x 1
.end_amdhsa_kernel
```
